```python
import torch

def _softmax(x, axis=-1):
    return torch.softmax(x, dim=axis)
def _gelu(x):
    return torch.nn.functional.gelu(x, approximate="tanh")
def _silu(x):
    return torch.nn.functional.silu(x)
def _sigmoid(x):
    return torch.sigmoid(x)
def _layernorm(x, axis=-1, eps=1e-5):
    m = x.mean(dim=axis, keepdim=True)
    v = x.var(dim=axis, keepdim=True, unbiased=False)
    return (x - m) / torch.sqrt(v + eps)
def _scatter_add(tgt, idx, src, axis=0):
    return tgt.clone().index_add_(axis, idx, src)
def _segment_sum(src, seg, n):
    out = torch.zeros((n,) + src.shape[1:], dtype=src.dtype)
    return out.index_add_(0, seg, src)
def _pad(x, pw):
    flat = tuple(v for pair in reversed(pw) for v in pair)
    return torch.nn.functional.pad(x, flat)

kernel_name = 'standalone__gqa_softmax__near_ridge'

def setup_inputs():

    _w = (lambda a: (lambda t: t.to(torch.bfloat16) if t.is_floating_point() else t)(torch.as_tensor(a)))
    B, Hq, Hkv, Sq, Sk, D = 8, 32, 16, 256, 1024, 128
    return {
        "q": _w((lambda *s: torch.randn(*s, dtype=torch.bfloat16) * 0.8)(B, Hq, Sq, D)),
        "k": _w((lambda *s: torch.randn(*s, dtype=torch.bfloat16) * 0.8)(B, Hkv, Sk, D)),
        "v": _w((lambda *s: torch.randn(*s, dtype=torch.bfloat16) * 0.05)(B, Hkv, Sk, D)),
    }

def reference(q, k, v):
    B, Hq, Sq, D = q.shape
    Hkv = k.shape[1]
    rep = Hq // Hkv
    k = (lambda x, n, axis: torch.repeat_interleave(x, n, dim=axis))(k, rep, axis=1)
    v = (lambda x, n, axis: torch.repeat_interleave(x, n, dim=axis))(v, rep, axis=1)
    scale = D ** -0.5
    scores = torch.einsum("bhqd,bhkd->bhqk", q, k) * scale
    p = _softmax(scores, axis=-1)
    return torch.einsum("bhqk,bhkd->bhqd", p, v)
```

```asm
; @launch grid=(256,1,1) block=(256,1,1) lds=163840
.amdgcn_target "amdgcn-amd-amdhsa--gfx950"
.text
.globl standalone__gqa_softmax__near_ridge_kernel
.p2align 8
.type standalone__gqa_softmax__near_ridge_kernel,@function
standalone__gqa_softmax__near_ridge_kernel:
  s_cmp_ge_u32 s2, 256
  s_cbranch_scc1 L_end
  s_load_dwordx4 s[4:7], s[0:1], 0
  s_load_dwordx4 s[8:11], s[0:1], 16
  s_getpc_b64 s[62:63]
L_pc0:
  v_lshlrev_b32 v255, 7, v0
  v_cmp_gt_u32 vcc, L_end-L_pc0+128, v255
  s_and_saveexec_b64 s[60:61], vcc
  s_cbranch_execz L_cpf_skip
  global_load_dword v254, v255, s[62:63]
L_cpf_skip:
  s_mov_b64 exec, s[60:61]
  v_lshrrev_b32 v248, 6, v0
  v_and_b32 v252, 63, v0
  v_readfirstlane_b32 s28, v248
  s_and_b32 s31, s2, 7
  s_lshr_b32 s32, s2, 3
  s_lshl_b32 s31, s31, 4
  s_lshr_b32 s33, s32, 1
  s_add_u32 s31, s31, s33
  s_and_b32 s32, s32, 1
  s_lshl_b32 s33, s31, 1
  s_add_u32 s32, s32, s33
  s_lshl_b32 s31, s31, 18
  s_lshl_b32 s32, s32, 16
  s_lshl_b32 s29, s28, 12
  v_lshrrev_b32 v247, 4, v252
  v_and_b32 v248, 15, v252
  v_xor_b32 v246, v248, v247
  v_lshlrev_b32 v246, 4, v246
  v_lshl_add_u32 v236, v247, 8, v246
  v_add_u32 v236, s29, v236
  v_xor_b32 v237, 0x40, v236
  v_xor_b32 v238, 0x80, v236
  v_xor_b32 v239, 0xc0, v236
  s_lshl_b32 s56, s28, 14
  s_cmp_lt_u32 s28, 2
  s_cselect_b32 s57, 2, 1
  s_lshl_b32 s57, s57, 16
  s_add_u32 s56, s56, s57
  s_mul_i32 s57, s28, 12288
  s_waitcnt lgkmcnt(0)
  s_add_u32 s12, s4, s32
  s_addc_u32 s13, s5, 0
  s_mov_b32 s14, 65536
  s_mov_b32 s15, 0x20000
  s_add_u32 m0, s56, 0
  s_add_u32 s33, s57, 0
  buffer_load_dwordx4 v236, s[12:15], s33 offen offset:0 nt lds
  buffer_load_dwordx4 v237, s[12:15], s33 offen offset:1024 nt lds
  buffer_load_dwordx4 v238, s[12:15], s33 offen offset:2048 nt lds
  buffer_load_dwordx4 v239, s[12:15], s33 offen offset:3072 nt lds
  s_add_u32 s16, s6, s31
  s_addc_u32 s17, s7, 0
  s_mov_b32 s18, 262144
  s_mov_b32 s19, 0x20000
  s_add_u32 m0, s29, 0
  s_mov_b32 s30, 0
  buffer_load_dwordx4 v236, s[16:19], s30 offen offset:0 nt lds
  buffer_load_dwordx4 v237, s[16:19], s30 offen offset:1024 nt lds
  buffer_load_dwordx4 v238, s[16:19], s30 offen offset:2048 nt lds
  buffer_load_dwordx4 v239, s[16:19], s30 offen offset:3072 nt lds
  s_add_u32 s20, s8, s31
  s_addc_u32 s21, s9, 0
  s_mov_b32 s22, 262144
  s_mov_b32 s23, 0x20000
  s_add_u32 s24, s10, s32
  s_addc_u32 s25, s11, 0
  s_mov_b32 s26, 65536
  s_mov_b32 s27, 0x20000
  v_lshl_add_u32 v224, v248, 8, v246
  v_xor_b32 v225, 0x40, v224
  v_xor_b32 v226, 0x80, v224
  v_xor_b32 v227, 0xc0, v224
  v_lshrrev_b32 v246, 2, v252
  v_lshlrev_b32 v228, 8, v246
  v_and_b32 v246, 7, v246
  v_lshl_add_u32 v228, v246, 4, v228
  v_and_b32 v246, 2, v252
  v_lshlrev_b32 v250, 6, v246
  v_and_b32 v246, 1, v252
  v_lshl_add_u32 v250, v246, 3, v250
  s_mov_b32 s36, 0x10000
  v_add3_u32 v228, v228, v250, s36
  v_xor_b32 v229, 0x10, v228
  v_xor_b32 v230, 0x20, v228
  v_xor_b32 v231, 0x30, v228
  v_xor_b32 v232, 0x40, v228
  v_xor_b32 v233, 0x50, v228
  v_xor_b32 v234, 0x60, v228
  v_xor_b32 v235, 0x70, v228
  v_mul_u32_u24 v240, 80, v247
  v_lshlrev_b32 v251, 4, v252
  v_lshlrev_b32 v241, 4, v248
  v_lshl_add_u32 v241, v247, 10, v241
  v_add_u32 v241, s29, v241
  v_xor_b32 v249, 64, v241
  v_lshl_add_u32 v250, v247, 8, v250
  v_and_b32 v246, 1, v247
  v_lshl_add_u32 v250, v246, 6, v250
  v_bfe_u32 v246, v252, 2, 2
  v_lshl_add_u32 v250, v246, 4, v250
  v_add_u32 v250, s29, v250
  v_add_u32 v220, s56, v224
  v_add_u32 v221, s56, v225
  v_add_u32 v222, s56, v226
  v_add_u32 v223, s56, v227
  s_mov_b32 s36, 0x3e0293ee
  s_mov_b32 s37, 0x3e0293ee
  v_mov_b32 v242, 0
  v_mov_b32 v243, 0
  v_mov_b32 v244, 0
  v_mov_b32 v245, 0
  v_mov_b32 v246, 0x3f803f80
  v_accvgpr_write_b32 a192, v246
  v_accvgpr_write_b32 a193, v246
  v_accvgpr_write_b32 a194, v246
  v_accvgpr_write_b32 a195, v246
  v_mov_b32 v0, 0
  v_mov_b32 v1, 0
  v_mov_b32 v2, 0
  v_mov_b32 v3, 0
  v_mov_b32 v4, 0
  v_mov_b32 v5, 0
  v_mov_b32 v6, 0
  v_mov_b32 v7, 0
  v_mov_b32 v8, 0
  v_mov_b32 v9, 0
  v_mov_b32 v10, 0
  v_mov_b32 v11, 0
  v_mov_b32 v12, 0
  v_mov_b32 v13, 0
  v_mov_b32 v14, 0
  v_mov_b32 v15, 0
  v_mov_b32 v16, 0
  v_mov_b32 v17, 0
  v_mov_b32 v18, 0
  v_mov_b32 v19, 0
  v_mov_b32 v20, 0
  v_mov_b32 v21, 0
  v_mov_b32 v22, 0
  v_mov_b32 v23, 0
  v_mov_b32 v24, 0
  v_mov_b32 v25, 0
  v_mov_b32 v26, 0
  v_mov_b32 v27, 0
  v_mov_b32 v28, 0
  v_mov_b32 v29, 0
  v_mov_b32 v30, 0
  v_mov_b32 v31, 0
  v_mov_b32 v32, 0
  v_mov_b32 v33, 0
  v_mov_b32 v34, 0
  v_mov_b32 v35, 0
  v_mov_b32 v36, 0
  v_mov_b32 v37, 0
  v_mov_b32 v38, 0
  v_mov_b32 v39, 0
  v_mov_b32 v40, 0
  v_mov_b32 v41, 0
  v_mov_b32 v42, 0
  v_mov_b32 v43, 0
  v_mov_b32 v44, 0
  v_mov_b32 v45, 0
  v_mov_b32 v46, 0
  v_mov_b32 v47, 0
  v_mov_b32 v48, 0
  v_mov_b32 v49, 0
  v_mov_b32 v50, 0
  v_mov_b32 v51, 0
  v_mov_b32 v52, 0
  v_mov_b32 v53, 0
  v_mov_b32 v54, 0
  v_mov_b32 v55, 0
  v_mov_b32 v56, 0
  v_mov_b32 v57, 0
  v_mov_b32 v58, 0
  v_mov_b32 v59, 0
  v_mov_b32 v60, 0
  v_mov_b32 v61, 0
  v_mov_b32 v62, 0
  v_mov_b32 v63, 0
  v_mov_b32 v64, 0
  v_mov_b32 v65, 0
  v_mov_b32 v66, 0
  v_mov_b32 v67, 0
  v_mov_b32 v68, 0
  v_mov_b32 v69, 0
  v_mov_b32 v70, 0
  v_mov_b32 v71, 0
  v_mov_b32 v72, 0
  v_mov_b32 v73, 0
  v_mov_b32 v74, 0
  v_mov_b32 v75, 0
  v_mov_b32 v76, 0
  v_mov_b32 v77, 0
  v_mov_b32 v78, 0
  v_mov_b32 v79, 0
  v_mov_b32 v80, 0
  v_mov_b32 v81, 0
  v_mov_b32 v82, 0
  v_mov_b32 v83, 0
  v_mov_b32 v84, 0
  v_mov_b32 v85, 0
  v_mov_b32 v86, 0
  v_mov_b32 v87, 0
  v_mov_b32 v88, 0
  v_mov_b32 v89, 0
  v_mov_b32 v90, 0
  v_mov_b32 v91, 0
  v_mov_b32 v92, 0
  v_mov_b32 v93, 0
  v_mov_b32 v94, 0
  v_mov_b32 v95, 0
  v_mov_b32 v96, 0
  v_mov_b32 v97, 0
  v_mov_b32 v98, 0
  v_mov_b32 v99, 0
  v_mov_b32 v100, 0
  v_mov_b32 v101, 0
  v_mov_b32 v102, 0
  v_mov_b32 v103, 0
  v_mov_b32 v104, 0
  v_mov_b32 v105, 0
  v_mov_b32 v106, 0
  v_mov_b32 v107, 0
  v_mov_b32 v108, 0
  v_mov_b32 v109, 0
  v_mov_b32 v110, 0
  v_mov_b32 v111, 0
  v_mov_b32 v112, 0
  v_mov_b32 v113, 0
  v_mov_b32 v114, 0
  v_mov_b32 v115, 0
  v_mov_b32 v116, 0
  v_mov_b32 v117, 0
  v_mov_b32 v118, 0
  v_mov_b32 v119, 0
  v_mov_b32 v120, 0
  v_mov_b32 v121, 0
  v_mov_b32 v122, 0
  v_mov_b32 v123, 0
  v_mov_b32 v124, 0
  v_mov_b32 v125, 0
  v_mov_b32 v126, 0
  v_mov_b32 v127, 0
  s_mov_b32 s34, s29
  s_add_u32 s59, s29, 0x8000
  s_mov_b32 s35, 7
  s_mov_b32 s3, 0xffff0000
  s_lshl_b32 s31, s28, 14
  s_add_u32 s32, s31, 4096
  s_add_u32 m0, s56, 4096
  s_add_u32 s33, s57, 4096
  buffer_load_dwordx4 v236, s[12:15], s33 offen offset:0 nt lds
  buffer_load_dwordx4 v237, s[12:15], s33 offen offset:1024 nt lds
  s_waitcnt vmcnt(6)
  ds_read_b128 v[160:163], v220 offset:0
  ds_read_b128 v[164:167], v221 offset:0
  ds_read_b128 v[168:171], v222 offset:0
  ds_read_b128 v[172:175], v223 offset:0
  buffer_load_dwordx4 v238, s[12:15], s33 offen offset:2048 nt lds
  buffer_load_dwordx4 v239, s[12:15], s33 offen offset:3072 nt lds
  s_waitcnt lgkmcnt(3)
  v_lshlrev_b32 v176, 16, v160
  v_and_b32 v177, s3, v160
  v_lshlrev_b32 v178, 16, v161
  v_and_b32 v179, s3, v161
  v_lshlrev_b32 v180, 16, v162
  v_and_b32 v181, s3, v162
  v_lshlrev_b32 v182, 16, v163
  v_and_b32 v183, s3, v163
  v_pk_mul_f32 v[176:177], v[176:177], s[36:37]
  v_pk_mul_f32 v[178:179], v[178:179], s[36:37]
  v_pk_mul_f32 v[180:181], v[180:181], s[36:37]
  v_pk_mul_f32 v[182:183], v[182:183], s[36:37]
  v_cvt_pk_bf16_f32 v160, v176, v177
  v_cvt_pk_bf16_f32 v161, v178, v179
  v_cvt_pk_bf16_f32 v162, v180, v181
  v_cvt_pk_bf16_f32 v163, v182, v183
  v_accvgpr_write_b32 a0, v160
  v_accvgpr_write_b32 a1, v161
  v_accvgpr_write_b32 a2, v162
  v_accvgpr_write_b32 a3, v163
  s_waitcnt lgkmcnt(2)
  v_lshlrev_b32 v176, 16, v164
  v_and_b32 v177, s3, v164
  v_lshlrev_b32 v178, 16, v165
  v_and_b32 v179, s3, v165
  v_lshlrev_b32 v180, 16, v166
  v_and_b32 v181, s3, v166
  v_lshlrev_b32 v182, 16, v167
  v_and_b32 v183, s3, v167
  v_pk_mul_f32 v[176:177], v[176:177], s[36:37]
  v_pk_mul_f32 v[178:179], v[178:179], s[36:37]
  v_pk_mul_f32 v[180:181], v[180:181], s[36:37]
  v_pk_mul_f32 v[182:183], v[182:183], s[36:37]
  v_cvt_pk_bf16_f32 v164, v176, v177
  v_cvt_pk_bf16_f32 v165, v178, v179
  v_cvt_pk_bf16_f32 v166, v180, v181
  v_cvt_pk_bf16_f32 v167, v182, v183
  v_accvgpr_write_b32 a4, v164
  v_accvgpr_write_b32 a5, v165
  v_accvgpr_write_b32 a6, v166
  v_accvgpr_write_b32 a7, v167
  s_waitcnt lgkmcnt(1)
  v_lshlrev_b32 v176, 16, v168
  v_and_b32 v177, s3, v168
  v_lshlrev_b32 v178, 16, v169
  v_and_b32 v179, s3, v169
  v_lshlrev_b32 v180, 16, v170
  v_and_b32 v181, s3, v170
  v_lshlrev_b32 v182, 16, v171
  v_and_b32 v183, s3, v171
  v_pk_mul_f32 v[176:177], v[176:177], s[36:37]
  v_pk_mul_f32 v[178:179], v[178:179], s[36:37]
  v_pk_mul_f32 v[180:181], v[180:181], s[36:37]
  v_pk_mul_f32 v[182:183], v[182:183], s[36:37]
  v_cvt_pk_bf16_f32 v168, v176, v177
  v_cvt_pk_bf16_f32 v169, v178, v179
  v_cvt_pk_bf16_f32 v170, v180, v181
  v_cvt_pk_bf16_f32 v171, v182, v183
  v_accvgpr_write_b32 a8, v168
  v_accvgpr_write_b32 a9, v169
  v_accvgpr_write_b32 a10, v170
  v_accvgpr_write_b32 a11, v171
  s_waitcnt lgkmcnt(0)
  v_lshlrev_b32 v176, 16, v172
  v_and_b32 v177, s3, v172
  v_lshlrev_b32 v178, 16, v173
  v_and_b32 v179, s3, v173
  v_lshlrev_b32 v180, 16, v174
  v_and_b32 v181, s3, v174
  v_lshlrev_b32 v182, 16, v175
  v_and_b32 v183, s3, v175
  v_pk_mul_f32 v[176:177], v[176:177], s[36:37]
  v_pk_mul_f32 v[178:179], v[178:179], s[36:37]
  v_pk_mul_f32 v[180:181], v[180:181], s[36:37]
  v_pk_mul_f32 v[182:183], v[182:183], s[36:37]
  v_cvt_pk_bf16_f32 v172, v176, v177
  v_cvt_pk_bf16_f32 v173, v178, v179
  v_cvt_pk_bf16_f32 v174, v180, v181
  v_cvt_pk_bf16_f32 v175, v182, v183
  v_accvgpr_write_b32 a12, v172
  v_accvgpr_write_b32 a13, v173
  v_accvgpr_write_b32 a14, v174
  v_accvgpr_write_b32 a15, v175
  s_add_u32 m0, s29, 65536
  s_mov_b32 s58, 0
  buffer_load_dwordx4 v236, s[20:23], s58 offen offset:0 nt lds
  buffer_load_dwordx4 v237, s[20:23], s58 offen offset:1024 nt lds
  s_waitcnt vmcnt(6)
  buffer_load_dwordx4 v236, s[20:23], s58 offen offset:2048 nt lds
  buffer_load_dwordx4 v237, s[20:23], s58 offen offset:3072 nt lds
  s_barrier
  ds_read_b128 a[64:67], v224 offset:0
  ds_read_b128 a[68:71], v225 offset:0
  ds_read_b128 a[72:75], v226 offset:0
  ds_read_b128 a[76:79], v227 offset:0
  ds_read_b128 a[80:83], v224 offset:4096
  ds_read_b128 a[84:87], v225 offset:4096
  ds_read_b128 a[88:91], v226 offset:4096
  ds_read_b128 a[92:95], v227 offset:4096
  ds_read_b128 a[96:99], v224 offset:8192
  ds_read_b128 a[100:103], v225 offset:8192
  ds_read_b128 a[104:107], v226 offset:8192
  ds_read_b128 a[108:111], v227 offset:8192
  ds_read_b128 a[112:115], v224 offset:12288
  ds_read_b128 a[116:119], v225 offset:12288
  ds_read_b128 a[120:123], v226 offset:12288
  ds_read_b128 a[124:127], v227 offset:12288
  s_waitcnt lgkmcnt(15)
  v_mfma_f32_16x16x32_bf16 v[128:131], a[64:67], a[0:3], 0
  s_waitcnt lgkmcnt(14)
  v_mfma_f32_16x16x32_bf16 v[128:131], a[68:71], a[4:7], v[128:131]
  s_waitcnt lgkmcnt(13)
  v_mfma_f32_16x16x32_bf16 v[128:131], a[72:75], a[8:11], v[128:131]
  s_waitcnt lgkmcnt(12)
  v_mfma_f32_16x16x32_bf16 v[128:131], a[76:79], a[12:15], v[128:131]
  s_waitcnt lgkmcnt(11)
  v_mfma_f32_16x16x32_bf16 v[132:135], a[80:83], a[0:3], 0
  s_waitcnt lgkmcnt(10)
  v_mfma_f32_16x16x32_bf16 v[132:135], a[84:87], a[4:7], v[132:135]
  s_waitcnt lgkmcnt(9)
  v_mfma_f32_16x16x32_bf16 v[132:135], a[88:91], a[8:11], v[132:135]
  s_waitcnt lgkmcnt(8)
  v_mfma_f32_16x16x32_bf16 v[132:135], a[92:95], a[12:15], v[132:135]
  s_waitcnt lgkmcnt(7)
  v_mfma_f32_16x16x32_bf16 v[136:139], a[96:99], a[0:3], 0
  s_waitcnt lgkmcnt(0)
  v_mfma_f32_16x16x32_bf16 v[136:139], a[100:103], a[4:7], v[136:139]
  v_mfma_f32_16x16x32_bf16 v[136:139], a[104:107], a[8:11], v[136:139]
  v_mfma_f32_16x16x32_bf16 v[136:139], a[108:111], a[12:15], v[136:139]
  v_mfma_f32_16x16x32_bf16 v[140:143], a[112:115], a[0:3], 0
  v_mfma_f32_16x16x32_bf16 v[140:143], a[116:119], a[4:7], v[140:143]
  v_mfma_f32_16x16x32_bf16 v[140:143], a[120:123], a[8:11], v[140:143]
  v_mfma_f32_16x16x32_bf16 v[140:143], a[124:127], a[12:15], v[140:143]
  s_add_u32 m0, s56, 8192
  s_add_u32 s33, s57, 8192
  buffer_load_dwordx4 v236, s[12:15], s33 offen offset:0 nt lds
  buffer_load_dwordx4 v237, s[12:15], s33 offen offset:1024 nt lds
  s_nop 7
  v_max3_f32 v246, v128, v129, v130
  v_max3_f32 v247, v131, v132, v133
  v_max3_f32 v246, v246, v134, v135
  v_max3_f32 v247, v247, v136, v137
  v_max3_f32 v246, v246, v138, v139
  v_max3_f32 v247, v247, v140, v141
  v_max3_f32 v246, v246, v142, v143
  v_max_f32 v246, v246, v247
  v_mov_b32 v247, v246
  s_nop 1
  v_permlane16_swap_b32 v246, v247
  s_nop 1
  v_max_f32 v246, v246, v247
  v_mov_b32 v247, v246
  s_nop 1
  v_permlane32_swap_b32 v246, v247
  s_nop 1
  v_max_f32 v246, v246, v247
  v_sub_f32 v192, 0, v246
  v_sub_f32 v193, 0, v246
  v_sub_f32 v194, 0, v246
  v_sub_f32 v195, 0, v246
  v_pk_add_f32 v[128:129], v[128:129], v[192:193]
  v_pk_add_f32 v[130:131], v[130:131], v[192:193]
  v_pk_add_f32 v[132:133], v[132:133], v[192:193]
  v_pk_add_f32 v[134:135], v[134:135], v[192:193]
  v_pk_add_f32 v[136:137], v[136:137], v[192:193]
  v_pk_add_f32 v[138:139], v[138:139], v[192:193]
  v_pk_add_f32 v[140:141], v[140:141], v[192:193]
  v_pk_add_f32 v[142:143], v[142:143], v[192:193]
  v_exp_f32 v128, v128
  v_exp_f32 v129, v129
  v_exp_f32 v130, v130
  v_cvt_pk_bf16_f32 v128, v128, v129
  v_exp_f32 v131, v131
  v_exp_f32 v132, v132
  v_cvt_pk_bf16_f32 v129, v130, v131
  v_exp_f32 v133, v133
  v_exp_f32 v134, v134
  v_cvt_pk_bf16_f32 v130, v132, v133
  v_exp_f32 v135, v135
  v_exp_f32 v136, v136
  v_cvt_pk_bf16_f32 v131, v134, v135
  s_nop 1
  v_mfma_f32_16x16x32_bf16 v[208:211], a[192:195], v[128:131], 0
  v_exp_f32 v137, v137
  v_exp_f32 v138, v138
  v_cvt_pk_bf16_f32 v136, v136, v137
  v_exp_f32 v139, v139
  v_exp_f32 v140, v140
  v_cvt_pk_bf16_f32 v137, v138, v139
  v_exp_f32 v141, v141
  v_exp_f32 v142, v142
  v_cvt_pk_bf16_f32 v138, v140, v141
  v_exp_f32 v143, v143
  s_nop 0
  v_cvt_pk_bf16_f32 v139, v142, v143
  s_nop 1
  v_mfma_f32_16x16x32_bf16 v[208:211], a[192:195], v[136:139], v[208:211]
  s_waitcnt vmcnt(6)
  ds_read_b128 v[160:163], v220 offset:4096
  ds_read_b128 v[164:167], v221 offset:4096
  ds_read_b128 v[168:171], v222 offset:4096
  ds_read_b128 v[172:175], v223 offset:4096
  buffer_load_dwordx4 v238, s[12:15], s33 offen offset:2048 nt lds
  buffer_load_dwordx4 v239, s[12:15], s33 offen offset:3072 nt lds
  s_waitcnt lgkmcnt(3)
  v_lshlrev_b32 v176, 16, v160
  v_and_b32 v177, s3, v160
  v_lshlrev_b32 v178, 16, v161
  v_and_b32 v179, s3, v161
  v_lshlrev_b32 v180, 16, v162
  v_and_b32 v181, s3, v162
  v_lshlrev_b32 v182, 16, v163
  v_and_b32 v183, s3, v163
  v_pk_mul_f32 v[176:177], v[176:177], s[36:37]
  v_pk_mul_f32 v[178:179], v[178:179], s[36:37]
  v_pk_mul_f32 v[180:181], v[180:181], s[36:37]
  v_pk_mul_f32 v[182:183], v[182:183], s[36:37]
  v_cvt_pk_bf16_f32 v160, v176, v177
  v_cvt_pk_bf16_f32 v161, v178, v179
  v_cvt_pk_bf16_f32 v162, v180, v181
  v_cvt_pk_bf16_f32 v163, v182, v183
  s_waitcnt lgkmcnt(2)
  v_lshlrev_b32 v176, 16, v164
  v_and_b32 v177, s3, v164
  v_lshlrev_b32 v178, 16, v165
  v_and_b32 v179, s3, v165
  v_lshlrev_b32 v180, 16, v166
  v_and_b32 v181, s3, v166
  v_lshlrev_b32 v182, 16, v167
  v_and_b32 v183, s3, v167
  v_pk_mul_f32 v[176:177], v[176:177], s[36:37]
  v_pk_mul_f32 v[178:179], v[178:179], s[36:37]
  v_pk_mul_f32 v[180:181], v[180:181], s[36:37]
  v_pk_mul_f32 v[182:183], v[182:183], s[36:37]
  v_mfma_f32_16x16x32_bf16 v[144:147], a[64:67], v[160:163], 0
  v_cvt_pk_bf16_f32 v164, v176, v177
  v_mfma_f32_16x16x32_bf16 v[148:151], a[80:83], v[160:163], 0
  v_cvt_pk_bf16_f32 v165, v178, v179
  v_mfma_f32_16x16x32_bf16 v[152:155], a[96:99], v[160:163], 0
  v_cvt_pk_bf16_f32 v166, v180, v181
  v_mfma_f32_16x16x32_bf16 v[156:159], a[112:115], v[160:163], 0
  v_cvt_pk_bf16_f32 v167, v182, v183
  s_waitcnt lgkmcnt(1)
  v_lshlrev_b32 v176, 16, v168
  v_and_b32 v177, s3, v168
  v_lshlrev_b32 v178, 16, v169
  v_and_b32 v179, s3, v169
  v_lshlrev_b32 v180, 16, v170
  v_and_b32 v181, s3, v170
  v_lshlrev_b32 v182, 16, v171
  v_and_b32 v183, s3, v171
  v_pk_mul_f32 v[176:177], v[176:177], s[36:37]
  v_pk_mul_f32 v[178:179], v[178:179], s[36:37]
  v_pk_mul_f32 v[180:181], v[180:181], s[36:37]
  v_pk_mul_f32 v[182:183], v[182:183], s[36:37]
  v_mfma_f32_16x16x32_bf16 v[144:147], a[68:71], v[164:167], v[144:147]
  v_cvt_pk_bf16_f32 v168, v176, v177
  v_mfma_f32_16x16x32_bf16 v[148:151], a[84:87], v[164:167], v[148:151]
  v_cvt_pk_bf16_f32 v169, v178, v179
  v_mfma_f32_16x16x32_bf16 v[152:155], a[100:103], v[164:167], v[152:155]
  v_cvt_pk_bf16_f32 v170, v180, v181
  v_mfma_f32_16x16x32_bf16 v[156:159], a[116:119], v[164:167], v[156:159]
  v_cvt_pk_bf16_f32 v171, v182, v183
  s_waitcnt lgkmcnt(0)
  v_lshlrev_b32 v176, 16, v172
  v_and_b32 v177, s3, v172
  v_lshlrev_b32 v178, 16, v173
  v_and_b32 v179, s3, v173
  v_lshlrev_b32 v180, 16, v174
  v_and_b32 v181, s3, v174
  v_lshlrev_b32 v182, 16, v175
  v_and_b32 v183, s3, v175
  v_pk_mul_f32 v[176:177], v[176:177], s[36:37]
  v_pk_mul_f32 v[178:179], v[178:179], s[36:37]
  v_pk_mul_f32 v[180:181], v[180:181], s[36:37]
  v_pk_mul_f32 v[182:183], v[182:183], s[36:37]
  v_mfma_f32_16x16x32_bf16 v[144:147], a[72:75], v[168:171], v[144:147]
  v_cvt_pk_bf16_f32 v172, v176, v177
  v_mfma_f32_16x16x32_bf16 v[148:151], a[88:91], v[168:171], v[148:151]
  v_cvt_pk_bf16_f32 v173, v178, v179
  v_mfma_f32_16x16x32_bf16 v[152:155], a[104:107], v[168:171], v[152:155]
  v_cvt_pk_bf16_f32 v174, v180, v181
  v_mfma_f32_16x16x32_bf16 v[156:159], a[120:123], v[168:171], v[156:159]
  v_cvt_pk_bf16_f32 v175, v182, v183
  v_accvgpr_write_b32 a16, v160
  v_accvgpr_write_b32 a17, v161
  v_mfma_f32_16x16x32_bf16 v[144:147], a[76:79], v[172:175], v[144:147]
  v_accvgpr_write_b32 a18, v162
  v_accvgpr_write_b32 a19, v163
  v_mfma_f32_16x16x32_bf16 v[148:151], a[92:95], v[172:175], v[148:151]
  v_accvgpr_write_b32 a20, v164
  v_accvgpr_write_b32 a21, v165
  v_mfma_f32_16x16x32_bf16 v[152:155], a[108:111], v[172:175], v[152:155]
  v_accvgpr_write_b32 a22, v166
  v_accvgpr_write_b32 a23, v167
  v_mfma_f32_16x16x32_bf16 v[156:159], a[124:127], v[172:175], v[156:159]
  v_accvgpr_write_b32 a24, v168
  v_accvgpr_write_b32 a25, v169
  v_accvgpr_write_b32 a26, v170
  v_accvgpr_write_b32 a27, v171
  v_accvgpr_write_b32 a28, v172
  v_accvgpr_write_b32 a29, v173
  v_accvgpr_write_b32 a30, v174
  v_accvgpr_write_b32 a31, v175
  v_max3_f32 v246, v144, v145, v146
  v_max3_f32 v247, v147, v148, v149
  v_max3_f32 v246, v246, v150, v151
  v_max3_f32 v247, v247, v152, v153
  v_max3_f32 v246, v246, v154, v155
  v_max3_f32 v247, v247, v156, v157
  v_max3_f32 v246, v246, v158, v159
  v_max_f32 v246, v246, v247
  v_mov_b32 v247, v246
  s_nop 1
  v_permlane16_swap_b32 v246, v247
  s_nop 1
  v_max_f32 v246, v246, v247
  v_mov_b32 v247, v246
  s_nop 1
  v_permlane32_swap_b32 v246, v247
  s_nop 1
  v_max_f32 v246, v246, v247
  v_sub_f32 v196, 0, v246
  v_sub_f32 v197, 0, v246
  v_sub_f32 v198, 0, v246
  v_sub_f32 v199, 0, v246
  v_pk_add_f32 v[144:145], v[144:145], v[196:197]
  v_pk_add_f32 v[146:147], v[146:147], v[196:197]
  v_pk_add_f32 v[148:149], v[148:149], v[196:197]
  v_pk_add_f32 v[150:151], v[150:151], v[196:197]
  v_pk_add_f32 v[152:153], v[152:153], v[196:197]
  v_pk_add_f32 v[154:155], v[154:155], v[196:197]
  v_pk_add_f32 v[156:157], v[156:157], v[196:197]
  v_pk_add_f32 v[158:159], v[158:159], v[196:197]
  s_add_u32 m0, s56, 12288
  s_add_u32 s33, s57, 12288
  buffer_load_dwordx4 v236, s[12:15], s33 offen offset:0 nt lds
  buffer_load_dwordx4 v237, s[12:15], s33 offen offset:1024 nt lds
  v_exp_f32 v144, v144
  v_exp_f32 v145, v145
  v_exp_f32 v146, v146
  v_cvt_pk_bf16_f32 v144, v144, v145
  v_exp_f32 v147, v147
  v_exp_f32 v148, v148
  v_cvt_pk_bf16_f32 v145, v146, v147
  v_exp_f32 v149, v149
  s_waitcnt vmcnt(6)
  buffer_load_dwordx4 v238, s[12:15], s33 offen offset:2048 nt lds
  buffer_load_dwordx4 v239, s[12:15], s33 offen offset:3072 nt lds
  s_barrier
  ds_read_b64_tr_b16 a[128:129], v228 offset:0
  ds_read_b64_tr_b16 a[130:131], v228 offset:4096
  ds_read_b64_tr_b16 a[132:133], v228 offset:8192
  ds_read_b64_tr_b16 a[134:135], v228 offset:12288
  ds_read_b64_tr_b16 a[136:137], v229 offset:0
  ds_read_b64_tr_b16 a[138:139], v229 offset:4096
  ds_read_b64_tr_b16 a[140:141], v229 offset:8192
  ds_read_b64_tr_b16 a[142:143], v229 offset:12288
  ds_read_b64_tr_b16 a[144:145], v230 offset:0
  ds_read_b64_tr_b16 a[146:147], v230 offset:4096
  ds_read_b64_tr_b16 a[148:149], v230 offset:8192
  ds_read_b64_tr_b16 a[150:151], v230 offset:12288
  v_exp_f32 v150, v150
  v_cvt_pk_bf16_f32 v146, v148, v149
  v_exp_f32 v151, v151
  v_exp_f32 v152, v152
  v_cvt_pk_bf16_f32 v147, v150, v151
  s_nop 1
  v_mfma_f32_16x16x32_bf16 v[212:215], a[192:195], v[144:147], 0
  s_waitcnt lgkmcnt(10)
  ds_read_b64_tr_b16 a[152:153], v231 offset:0
  ds_read_b64_tr_b16 a[154:155], v231 offset:4096
  ds_read_b64_tr_b16 a[156:157], v231 offset:8192
  ds_read_b64_tr_b16 a[158:159], v231 offset:12288
  ds_read_b64_tr_b16 a[160:161], v232 offset:0
  ds_read_b64_tr_b16 a[162:163], v232 offset:4096
  ds_read_b64_tr_b16 a[164:165], v232 offset:8192
  ds_read_b64_tr_b16 a[166:167], v232 offset:12288
  v_mfma_f32_16x16x32_bf16 v[0:3], v[128:131], a[128:131], v[0:3]
  s_waitcnt lgkmcnt(15)
  ds_read_b64_tr_b16 a[168:169], v233 offset:0
  ds_read_b64_tr_b16 a[170:171], v233 offset:4096
  v_mfma_f32_16x16x32_bf16 v[0:3], v[136:139], a[132:135], v[0:3]
  s_waitcnt lgkmcnt(14)
  ds_read_b64_tr_b16 a[172:173], v233 offset:8192
  ds_read_b64_tr_b16 a[174:175], v233 offset:12288
  v_mfma_f32_16x16x32_bf16 v[4:7], v[136:139], a[140:143], v[4:7]
  ds_read_b64_tr_b16 a[176:177], v234 offset:0
  ds_read_b64_tr_b16 a[178:179], v234 offset:4096
  v_mfma_f32_16x16x32_bf16 v[4:7], v[128:131], a[136:139], v[4:7]
  s_waitcnt lgkmcnt(15)
  ds_read_b64_tr_b16 a[180:181], v234 offset:8192
  ds_read_b64_tr_b16 a[182:183], v234 offset:12288
  v_mfma_f32_16x16x32_bf16 v[8:11], v[128:131], a[144:147], v[8:11]
  s_waitcnt lgkmcnt(15)
  ds_read_b64_tr_b16 a[184:185], v235 offset:0
  ds_read_b64_tr_b16 a[186:187], v235 offset:4096
  v_mfma_f32_16x16x32_bf16 v[8:11], v[136:139], a[148:151], v[8:11]
  s_waitcnt lgkmcnt(14)
  ds_read_b64_tr_b16 a[188:189], v235 offset:8192
  ds_read_b64_tr_b16 a[190:191], v235 offset:12288
  v_mfma_f32_16x16x32_bf16 v[12:15], v[136:139], a[156:159], v[12:15]
  v_exp_f32 v153, v153
  v_mfma_f32_16x16x32_bf16 v[12:15], v[128:131], a[152:155], v[12:15]
  s_waitcnt lgkmcnt(14)
  v_exp_f32 v154, v154
  v_mfma_f32_16x16x32_bf16 v[16:19], v[128:131], a[160:163], v[16:19]
  s_waitcnt lgkmcnt(12)
  v_cvt_pk_bf16_f32 v152, v152, v153
  v_mfma_f32_16x16x32_bf16 v[16:19], v[136:139], a[164:167], v[16:19]
  s_waitcnt lgkmcnt(8)
  v_exp_f32 v155, v155
  v_mfma_f32_16x16x32_bf16 v[20:23], v[136:139], a[172:175], v[20:23]
  v_exp_f32 v156, v156
  v_mfma_f32_16x16x32_bf16 v[20:23], v[128:131], a[168:171], v[20:23]
  s_waitcnt lgkmcnt(6)
  v_cvt_pk_bf16_f32 v153, v154, v155
  v_mfma_f32_16x16x32_bf16 v[24:27], v[128:131], a[176:179], v[24:27]
  s_waitcnt lgkmcnt(4)
  v_exp_f32 v157, v157
  v_mfma_f32_16x16x32_bf16 v[24:27], v[136:139], a[180:183], v[24:27]
  s_waitcnt lgkmcnt(0)
  v_exp_f32 v158, v158
  v_mfma_f32_16x16x32_bf16 v[28:31], v[136:139], a[188:191], v[28:31]
  v_cvt_pk_bf16_f32 v154, v156, v157
  v_mfma_f32_16x16x32_bf16 v[28:31], v[128:131], a[184:187], v[28:31]
  v_exp_f32 v159, v159
  s_nop 0
  v_cvt_pk_bf16_f32 v155, v158, v159
  s_nop 1
  v_mfma_f32_16x16x32_bf16 v[212:215], a[192:195], v[152:155], v[212:215]
  s_nop 1
  s_add_u32 m0, s29, 16384
  s_mov_b32 s30, 16384
  buffer_load_dwordx4 v236, s[16:19], s30 offen offset:0 nt lds
  buffer_load_dwordx4 v237, s[16:19], s30 offen offset:1024 nt lds
  s_waitcnt vmcnt(6)
  ds_read_b128 v[128:131], v220 offset:8192
  ds_read_b128 v[132:135], v221 offset:8192
  ds_read_b128 v[136:139], v222 offset:8192
  ds_read_b128 v[140:143], v223 offset:8192
  buffer_load_dwordx4 v238, s[16:19], s30 offen offset:2048 nt lds
  buffer_load_dwordx4 v239, s[16:19], s30 offen offset:3072 nt lds
  v_mfma_f32_16x16x32_bf16 v[32:35], v[144:147], a[128:131], v[32:35]
  v_mfma_f32_16x16x32_bf16 v[32:35], v[152:155], a[132:135], v[32:35]
  v_mfma_f32_16x16x32_bf16 v[36:39], v[152:155], a[140:143], v[36:39]
  v_mfma_f32_16x16x32_bf16 v[36:39], v[144:147], a[136:139], v[36:39]
  v_mfma_f32_16x16x32_bf16 v[40:43], v[144:147], a[144:147], v[40:43]
  v_mfma_f32_16x16x32_bf16 v[40:43], v[152:155], a[148:151], v[40:43]
  v_mfma_f32_16x16x32_bf16 v[44:47], v[152:155], a[156:159], v[44:47]
  v_mfma_f32_16x16x32_bf16 v[44:47], v[144:147], a[152:155], v[44:47]
  v_mfma_f32_16x16x32_bf16 v[48:51], v[144:147], a[160:163], v[48:51]
  v_mfma_f32_16x16x32_bf16 v[48:51], v[152:155], a[164:167], v[48:51]
  v_mfma_f32_16x16x32_bf16 v[52:55], v[152:155], a[172:175], v[52:55]
  v_mfma_f32_16x16x32_bf16 v[52:55], v[144:147], a[168:171], v[52:55]
  v_mfma_f32_16x16x32_bf16 v[56:59], v[144:147], a[176:179], v[56:59]
  v_mfma_f32_16x16x32_bf16 v[56:59], v[152:155], a[180:183], v[56:59]
  v_mfma_f32_16x16x32_bf16 v[60:63], v[152:155], a[188:191], v[60:63]
  v_mfma_f32_16x16x32_bf16 v[60:63], v[144:147], a[184:187], v[60:63]
  v_add_f32 v242, v242, v208
  v_add_f32 v243, v243, v212
  s_waitcnt lgkmcnt(3)
  v_lshlrev_b32 v184, 16, v128
  v_and_b32 v185, s3, v128
  v_lshlrev_b32 v186, 16, v129
  v_and_b32 v187, s3, v129
  v_lshlrev_b32 v188, 16, v130
  v_and_b32 v189, s3, v130
  v_lshlrev_b32 v190, 16, v131
  v_and_b32 v191, s3, v131
  v_pk_mul_f32 v[184:185], v[184:185], s[36:37]
  v_pk_mul_f32 v[186:187], v[186:187], s[36:37]
  v_pk_mul_f32 v[188:189], v[188:189], s[36:37]
  v_pk_mul_f32 v[190:191], v[190:191], s[36:37]
  v_cvt_pk_bf16_f32 v128, v184, v185
  v_cvt_pk_bf16_f32 v129, v186, v187
  v_cvt_pk_bf16_f32 v130, v188, v189
  v_cvt_pk_bf16_f32 v131, v190, v191
  s_waitcnt lgkmcnt(2)
  v_lshlrev_b32 v184, 16, v132
  v_and_b32 v185, s3, v132
  v_lshlrev_b32 v186, 16, v133
  v_and_b32 v187, s3, v133
  v_lshlrev_b32 v188, 16, v134
  v_and_b32 v189, s3, v134
  v_lshlrev_b32 v190, 16, v135
  v_and_b32 v191, s3, v135
  v_pk_mul_f32 v[184:185], v[184:185], s[36:37]
  v_pk_mul_f32 v[186:187], v[186:187], s[36:37]
  v_pk_mul_f32 v[188:189], v[188:189], s[36:37]
  v_pk_mul_f32 v[190:191], v[190:191], s[36:37]
  v_mfma_f32_16x16x32_bf16 v[160:163], a[64:67], v[128:131], 0
  v_cvt_pk_bf16_f32 v132, v184, v185
  v_mfma_f32_16x16x32_bf16 v[164:167], a[80:83], v[128:131], 0
  v_cvt_pk_bf16_f32 v133, v186, v187
  v_mfma_f32_16x16x32_bf16 v[168:171], a[96:99], v[128:131], 0
  v_cvt_pk_bf16_f32 v134, v188, v189
  v_mfma_f32_16x16x32_bf16 v[172:175], a[112:115], v[128:131], 0
  v_cvt_pk_bf16_f32 v135, v190, v191
  s_waitcnt lgkmcnt(1)
  v_lshlrev_b32 v184, 16, v136
  v_and_b32 v185, s3, v136
  v_lshlrev_b32 v186, 16, v137
  v_and_b32 v187, s3, v137
  v_lshlrev_b32 v188, 16, v138
  v_and_b32 v189, s3, v138
  v_lshlrev_b32 v190, 16, v139
  v_and_b32 v191, s3, v139
  v_pk_mul_f32 v[184:185], v[184:185], s[36:37]
  v_pk_mul_f32 v[186:187], v[186:187], s[36:37]
  v_pk_mul_f32 v[188:189], v[188:189], s[36:37]
  v_pk_mul_f32 v[190:191], v[190:191], s[36:37]
  v_mfma_f32_16x16x32_bf16 v[160:163], a[68:71], v[132:135], v[160:163]
  v_cvt_pk_bf16_f32 v136, v184, v185
  v_mfma_f32_16x16x32_bf16 v[164:167], a[84:87], v[132:135], v[164:167]
  v_cvt_pk_bf16_f32 v137, v186, v187
  v_mfma_f32_16x16x32_bf16 v[168:171], a[100:103], v[132:135], v[168:171]
  v_cvt_pk_bf16_f32 v138, v188, v189
  v_mfma_f32_16x16x32_bf16 v[172:175], a[116:119], v[132:135], v[172:175]
  v_cvt_pk_bf16_f32 v139, v190, v191
  s_waitcnt lgkmcnt(0)
  v_lshlrev_b32 v184, 16, v140
  v_and_b32 v185, s3, v140
  v_lshlrev_b32 v186, 16, v141
  v_and_b32 v187, s3, v141
  v_lshlrev_b32 v188, 16, v142
  v_and_b32 v189, s3, v142
  v_lshlrev_b32 v190, 16, v143
  v_and_b32 v191, s3, v143
  v_pk_mul_f32 v[184:185], v[184:185], s[36:37]
  v_pk_mul_f32 v[186:187], v[186:187], s[36:37]
  v_pk_mul_f32 v[188:189], v[188:189], s[36:37]
  v_pk_mul_f32 v[190:191], v[190:191], s[36:37]
  v_mfma_f32_16x16x32_bf16 v[160:163], a[72:75], v[136:139], v[160:163]
  v_cvt_pk_bf16_f32 v140, v184, v185
  v_mfma_f32_16x16x32_bf16 v[164:167], a[88:91], v[136:139], v[164:167]
  v_cvt_pk_bf16_f32 v141, v186, v187
  v_mfma_f32_16x16x32_bf16 v[168:171], a[104:107], v[136:139], v[168:171]
  v_cvt_pk_bf16_f32 v142, v188, v189
  v_mfma_f32_16x16x32_bf16 v[172:175], a[120:123], v[136:139], v[172:175]
  v_cvt_pk_bf16_f32 v143, v190, v191
  v_accvgpr_write_b32 a32, v128
  v_accvgpr_write_b32 a33, v129
  v_mfma_f32_16x16x32_bf16 v[160:163], a[76:79], v[140:143], v[160:163]
  v_accvgpr_write_b32 a34, v130
  v_accvgpr_write_b32 a35, v131
  v_mfma_f32_16x16x32_bf16 v[164:167], a[92:95], v[140:143], v[164:167]
  v_accvgpr_write_b32 a36, v132
  v_accvgpr_write_b32 a37, v133
  v_mfma_f32_16x16x32_bf16 v[168:171], a[108:111], v[140:143], v[168:171]
  v_accvgpr_write_b32 a38, v134
  v_accvgpr_write_b32 a39, v135
  v_mfma_f32_16x16x32_bf16 v[172:175], a[124:127], v[140:143], v[172:175]
  v_accvgpr_write_b32 a40, v136
  v_accvgpr_write_b32 a41, v137
  v_accvgpr_write_b32 a42, v138
  v_accvgpr_write_b32 a43, v139
  v_accvgpr_write_b32 a44, v140
  v_accvgpr_write_b32 a45, v141
  v_accvgpr_write_b32 a46, v142
  v_accvgpr_write_b32 a47, v143
  v_max3_f32 v246, v160, v161, v162
  v_max3_f32 v247, v163, v164, v165
  v_max3_f32 v246, v246, v166, v167
  v_max3_f32 v247, v247, v168, v169
  v_max3_f32 v246, v246, v170, v171
  v_max3_f32 v247, v247, v172, v173
  v_max3_f32 v246, v246, v174, v175
  v_max_f32 v246, v246, v247
  v_mov_b32 v247, v246
  s_nop 1
  v_permlane16_swap_b32 v246, v247
  s_nop 1
  v_max_f32 v246, v246, v247
  v_mov_b32 v247, v246
  s_nop 1
  v_permlane32_swap_b32 v246, v247
  s_nop 1
  v_max_f32 v246, v246, v247
  v_sub_f32 v200, 0, v246
  v_sub_f32 v201, 0, v246
  v_sub_f32 v202, 0, v246
  v_sub_f32 v203, 0, v246
  v_pk_add_f32 v[160:161], v[160:161], v[200:201]
  v_pk_add_f32 v[162:163], v[162:163], v[200:201]
  v_pk_add_f32 v[164:165], v[164:165], v[200:201]
  v_pk_add_f32 v[166:167], v[166:167], v[200:201]
  v_pk_add_f32 v[168:169], v[168:169], v[200:201]
  v_pk_add_f32 v[170:171], v[170:171], v[200:201]
  v_pk_add_f32 v[172:173], v[172:173], v[200:201]
  v_pk_add_f32 v[174:175], v[174:175], v[200:201]
  v_exp_f32 v160, v160
  v_exp_f32 v161, v161
  v_exp_f32 v162, v162
  v_cvt_pk_bf16_f32 v160, v160, v161
  v_exp_f32 v163, v163
  v_exp_f32 v164, v164
  v_cvt_pk_bf16_f32 v161, v162, v163
  v_exp_f32 v165, v165
  v_exp_f32 v166, v166
  v_cvt_pk_bf16_f32 v162, v164, v165
  v_exp_f32 v167, v167
  v_exp_f32 v168, v168
  v_cvt_pk_bf16_f32 v163, v166, v167
  s_nop 1
  v_mfma_f32_16x16x32_bf16 v[216:219], a[192:195], v[160:163], 0
  v_exp_f32 v169, v169
  v_exp_f32 v170, v170
  v_cvt_pk_bf16_f32 v168, v168, v169
  v_exp_f32 v171, v171
  v_exp_f32 v172, v172
  v_cvt_pk_bf16_f32 v169, v170, v171
  v_exp_f32 v173, v173
  v_exp_f32 v174, v174
  v_cvt_pk_bf16_f32 v170, v172, v173
  v_exp_f32 v175, v175
  s_add_u32 m0, s29, 32768
  s_mov_b32 s30, 32768
  buffer_load_dwordx4 v236, s[16:19], s30 offen offset:0 nt lds
  buffer_load_dwordx4 v237, s[16:19], s30 offen offset:1024 nt lds
  s_waitcnt vmcnt(6)
  ds_read_b128 v[128:131], v220 offset:12288
  ds_read_b128 v[132:135], v221 offset:12288
  ds_read_b128 v[136:139], v222 offset:12288
  ds_read_b128 v[140:143], v223 offset:12288
  buffer_load_dwordx4 v238, s[16:19], s30 offen offset:2048 nt lds
  buffer_load_dwordx4 v239, s[16:19], s30 offen offset:3072 nt lds
  s_waitcnt lgkmcnt(3)
  v_lshlrev_b32 v144, 16, v128
  v_and_b32 v145, s3, v128
  v_lshlrev_b32 v146, 16, v129
  v_and_b32 v147, s3, v129
  v_lshlrev_b32 v148, 16, v130
  v_and_b32 v149, s3, v130
  v_lshlrev_b32 v150, 16, v131
  v_and_b32 v151, s3, v131
  v_pk_mul_f32 v[144:145], v[144:145], s[36:37]
  v_pk_mul_f32 v[146:147], v[146:147], s[36:37]
  v_pk_mul_f32 v[148:149], v[148:149], s[36:37]
  v_pk_mul_f32 v[150:151], v[150:151], s[36:37]
  v_cvt_pk_bf16_f32 v128, v144, v145
  v_cvt_pk_bf16_f32 v129, v146, v147
  v_cvt_pk_bf16_f32 v130, v148, v149
  v_cvt_pk_bf16_f32 v131, v150, v151
  s_waitcnt lgkmcnt(2)
  v_lshlrev_b32 v144, 16, v132
  v_and_b32 v145, s3, v132
  v_lshlrev_b32 v146, 16, v133
  v_and_b32 v147, s3, v133
  v_lshlrev_b32 v148, 16, v134
  v_and_b32 v149, s3, v134
  v_lshlrev_b32 v150, 16, v135
  v_and_b32 v151, s3, v135
  v_pk_mul_f32 v[144:145], v[144:145], s[36:37]
  v_pk_mul_f32 v[146:147], v[146:147], s[36:37]
  v_pk_mul_f32 v[148:149], v[148:149], s[36:37]
  v_pk_mul_f32 v[150:151], v[150:151], s[36:37]
  v_mfma_f32_16x16x32_bf16 v[176:179], a[64:67], v[128:131], 0
  v_cvt_pk_bf16_f32 v132, v144, v145
  v_mfma_f32_16x16x32_bf16 v[180:183], a[80:83], v[128:131], 0
  v_cvt_pk_bf16_f32 v133, v146, v147
  v_mfma_f32_16x16x32_bf16 v[184:187], a[96:99], v[128:131], 0
  v_cvt_pk_bf16_f32 v134, v148, v149
  v_mfma_f32_16x16x32_bf16 v[188:191], a[112:115], v[128:131], 0
  v_cvt_pk_bf16_f32 v135, v150, v151
  s_waitcnt lgkmcnt(1)
  v_lshlrev_b32 v144, 16, v136
  v_and_b32 v145, s3, v136
  v_lshlrev_b32 v146, 16, v137
  v_and_b32 v147, s3, v137
  v_lshlrev_b32 v148, 16, v138
  v_and_b32 v149, s3, v138
  v_lshlrev_b32 v150, 16, v139
  v_and_b32 v151, s3, v139
  v_pk_mul_f32 v[144:145], v[144:145], s[36:37]
  v_pk_mul_f32 v[146:147], v[146:147], s[36:37]
  v_pk_mul_f32 v[148:149], v[148:149], s[36:37]
  v_pk_mul_f32 v[150:151], v[150:151], s[36:37]
  v_mfma_f32_16x16x32_bf16 v[176:179], a[68:71], v[132:135], v[176:179]
  v_cvt_pk_bf16_f32 v136, v144, v145
  v_mfma_f32_16x16x32_bf16 v[180:183], a[84:87], v[132:135], v[180:183]
  v_cvt_pk_bf16_f32 v137, v146, v147
  v_mfma_f32_16x16x32_bf16 v[184:187], a[100:103], v[132:135], v[184:187]
  v_cvt_pk_bf16_f32 v138, v148, v149
  v_mfma_f32_16x16x32_bf16 v[188:191], a[116:119], v[132:135], v[188:191]
  v_cvt_pk_bf16_f32 v139, v150, v151
  s_waitcnt lgkmcnt(0)
  v_lshlrev_b32 v144, 16, v140
  v_and_b32 v145, s3, v140
  v_lshlrev_b32 v146, 16, v141
  v_and_b32 v147, s3, v141
  v_lshlrev_b32 v148, 16, v142
  v_and_b32 v149, s3, v142
  v_lshlrev_b32 v150, 16, v143
  v_and_b32 v151, s3, v143
  v_pk_mul_f32 v[144:145], v[144:145], s[36:37]
  v_pk_mul_f32 v[146:147], v[146:147], s[36:37]
  v_pk_mul_f32 v[148:149], v[148:149], s[36:37]
  v_pk_mul_f32 v[150:151], v[150:151], s[36:37]
  v_mfma_f32_16x16x32_bf16 v[176:179], a[72:75], v[136:139], v[176:179]
  v_cvt_pk_bf16_f32 v140, v144, v145
  v_mfma_f32_16x16x32_bf16 v[180:183], a[88:91], v[136:139], v[180:183]
  v_cvt_pk_bf16_f32 v141, v146, v147
  v_mfma_f32_16x16x32_bf16 v[184:187], a[104:107], v[136:139], v[184:187]
  v_cvt_pk_bf16_f32 v142, v148, v149
  v_mfma_f32_16x16x32_bf16 v[188:191], a[120:123], v[136:139], v[188:191]
  v_cvt_pk_bf16_f32 v143, v150, v151
  v_accvgpr_write_b32 a48, v128
  v_accvgpr_write_b32 a49, v129
  v_mfma_f32_16x16x32_bf16 v[176:179], a[76:79], v[140:143], v[176:179]
  v_accvgpr_write_b32 a50, v130
  v_accvgpr_write_b32 a51, v131
  v_mfma_f32_16x16x32_bf16 v[180:183], a[92:95], v[140:143], v[180:183]
  v_accvgpr_write_b32 a52, v132
  v_accvgpr_write_b32 a53, v133
  v_mfma_f32_16x16x32_bf16 v[184:187], a[108:111], v[140:143], v[184:187]
  v_accvgpr_write_b32 a54, v134
  v_accvgpr_write_b32 a55, v135
  v_mfma_f32_16x16x32_bf16 v[188:191], a[124:127], v[140:143], v[188:191]
  v_accvgpr_write_b32 a56, v136
  v_accvgpr_write_b32 a57, v137
  v_accvgpr_write_b32 a58, v138
  v_accvgpr_write_b32 a59, v139
  v_accvgpr_write_b32 a60, v140
  v_accvgpr_write_b32 a61, v141
  v_accvgpr_write_b32 a62, v142
  v_accvgpr_write_b32 a63, v143
  v_max3_f32 v246, v176, v177, v178
  v_max3_f32 v247, v179, v180, v181
  v_max3_f32 v246, v246, v182, v183
  v_max3_f32 v247, v247, v184, v185
  v_max3_f32 v246, v246, v186, v187
  v_max3_f32 v247, v247, v188, v189
  v_max3_f32 v246, v246, v190, v191
  v_max_f32 v246, v246, v247
  v_mov_b32 v247, v246
  s_nop 1
  v_permlane16_swap_b32 v246, v247
  s_nop 1
  v_max_f32 v246, v246, v247
  v_mov_b32 v247, v246
  s_nop 1
  v_permlane32_swap_b32 v246, v247
  s_nop 1
  v_max_f32 v246, v246, v247
  v_sub_f32 v204, 0, v246
  v_sub_f32 v205, 0, v246
  s_waitcnt vmcnt(4)
  s_barrier
  ds_read_b128 a[64:67], v224 offset:16384
  ds_read_b128 a[68:71], v225 offset:16384
  ds_read_b128 a[72:75], v226 offset:16384
  ds_read_b128 a[76:79], v227 offset:16384
  ds_read_b128 a[80:83], v224 offset:20480
  ds_read_b128 a[84:87], v225 offset:20480
  ds_read_b128 a[88:91], v226 offset:20480
  ds_read_b128 a[92:95], v227 offset:20480
  ds_read_b128 a[96:99], v224 offset:24576
  v_sub_f32 v206, 0, v246
  v_sub_f32 v207, 0, v246
  v_pk_add_f32 v[176:177], v[176:177], v[204:205]
  v_pk_add_f32 v[178:179], v[178:179], v[204:205]
  v_pk_add_f32 v[180:181], v[180:181], v[204:205]
  v_pk_add_f32 v[182:183], v[182:183], v[204:205]
  v_pk_add_f32 v[184:185], v[184:185], v[204:205]
  v_pk_add_f32 v[186:187], v[186:187], v[204:205]
  v_pk_add_f32 v[188:189], v[188:189], v[204:205]
  v_pk_add_f32 v[190:191], v[190:191], v[204:205]
  v_exp_f32 v176, v176
  v_cvt_pk_bf16_f32 v171, v174, v175
  s_nop 1
  v_mfma_f32_16x16x32_bf16 v[216:219], a[192:195], v[168:171], v[216:219]
  s_add_u32 m0, s29, 81920
  s_mov_b32 s58, 16384
  buffer_load_dwordx4 v236, s[20:23], s58 offen offset:0 nt lds
  buffer_load_dwordx4 v237, s[20:23], s58 offen offset:1024 nt lds
  buffer_load_dwordx4 v236, s[20:23], s58 offen offset:2048 nt lds
  buffer_load_dwordx4 v237, s[20:23], s58 offen offset:3072 nt lds
  s_add_u32 m0, s29, 49152
  s_mov_b32 s30, 49152
  buffer_load_dwordx4 v236, s[16:19], s30 offen offset:0 nt lds
  buffer_load_dwordx4 v237, s[16:19], s30 offen offset:1024 nt lds
  buffer_load_dwordx4 v238, s[16:19], s30 offen offset:2048 nt lds
  buffer_load_dwordx4 v239, s[16:19], s30 offen offset:3072 nt lds
  s_waitcnt lgkmcnt(8)
  v_mfma_f32_16x16x32_bf16 v[128:131], a[64:67], a[0:3], v[192:195]
  s_waitcnt lgkmcnt(7)
  v_exp_f32 v177, v177
  v_mfma_f32_16x16x32_bf16 v[128:131], a[68:71], a[4:7], v[128:131]
  s_waitcnt lgkmcnt(6)
  v_exp_f32 v178, v178
  v_mfma_f32_16x16x32_bf16 v[128:131], a[72:75], a[8:11], v[128:131]
  s_waitcnt lgkmcnt(5)
  ds_read_b128 a[100:103], v225 offset:24576
  v_cvt_pk_bf16_f32 v176, v176, v177
  v_mfma_f32_16x16x32_bf16 v[128:131], a[76:79], a[12:15], v[128:131]
  v_exp_f32 v179, v179
  v_mfma_f32_16x16x32_bf16 v[144:147], a[76:79], a[28:31], v[196:199]
  v_exp_f32 v180, v180
  v_mfma_f32_16x16x32_bf16 v[144:147], a[72:75], a[24:27], v[144:147]
  ds_read_b128 a[104:107], v226 offset:24576
  v_cvt_pk_bf16_f32 v177, v178, v179
  v_mfma_f32_16x16x32_bf16 v[144:147], a[68:71], a[20:23], v[144:147]
  v_exp_f32 v181, v181
  v_mfma_f32_16x16x32_bf16 v[144:147], a[64:67], a[16:19], v[144:147]
  s_waitcnt lgkmcnt(6)
  v_exp_f32 v182, v182
  v_mfma_f32_16x16x32_bf16 v[148:151], a[80:83], a[16:19], v[196:199]
  s_waitcnt lgkmcnt(2)
  ds_read_b128 a[108:111], v227 offset:24576
  v_cvt_pk_bf16_f32 v178, v180, v181
  v_mfma_f32_16x16x32_bf16 v[148:151], a[84:87], a[20:23], v[148:151]
  v_exp_f32 v183, v183
  v_mfma_f32_16x16x32_bf16 v[148:151], a[88:91], a[24:27], v[148:151]
  v_exp_f32 v184, v184
  v_mfma_f32_16x16x32_bf16 v[148:151], a[92:95], a[28:31], v[148:151]
  ds_read_b128 a[112:115], v224 offset:28672
  v_cvt_pk_bf16_f32 v179, v182, v183
  v_mfma_f32_16x16x32_bf16 v[132:135], a[92:95], a[12:15], v[192:195]
  v_exp_f32 v185, v185
  v_mfma_f32_16x16x32_bf16 v[132:135], a[88:91], a[8:11], v[132:135]
  v_exp_f32 v186, v186
  v_mfma_f32_16x16x32_bf16 v[132:135], a[84:87], a[4:7], v[132:135]
  ds_read_b128 a[116:119], v225 offset:28672
  v_cvt_pk_bf16_f32 v184, v184, v185
  v_mfma_f32_16x16x32_bf16 v[132:135], a[80:83], a[0:3], v[132:135]
  v_exp_f32 v187, v187
  v_mfma_f32_16x16x32_bf16 v[220:223], a[192:195], v[176:179], 0
  v_exp_f32 v188, v188
  v_mfma_f32_16x16x32_bf16 v[136:139], a[96:99], a[0:3], v[192:195]
  s_waitcnt lgkmcnt(2)
  ds_read_b128 a[120:123], v226 offset:28672
  v_cvt_pk_bf16_f32 v185, v186, v187
  v_mfma_f32_16x16x32_bf16 v[136:139], a[100:103], a[4:7], v[136:139]
  v_exp_f32 v189, v189
  v_mfma_f32_16x16x32_bf16 v[136:139], a[104:107], a[8:11], v[136:139]
  v_exp_f32 v190, v190
  v_mfma_f32_16x16x32_bf16 v[136:139], a[108:111], a[12:15], v[136:139]
  s_add_u32 m0, s29, 98304
  ds_read_b128 a[124:127], v227 offset:28672
  v_cvt_pk_bf16_f32 v186, v188, v189
  v_mfma_f32_16x16x32_bf16 v[152:155], a[108:111], a[28:31], v[196:199]
  s_mov_b32 s58, 32768
  v_exp_f32 v191, v191
  v_mfma_f32_16x16x32_bf16 v[152:155], a[104:107], a[24:27], v[152:155]
  v_cvt_pk_bf16_f32 v187, v190, v191
  v_xor_b32 v224, 0x8000, v224
  v_mfma_f32_16x16x32_bf16 v[152:155], a[100:103], a[20:23], v[152:155]
  v_xor_b32 v225, 0x8000, v225
  v_xor_b32 v226, 0x8000, v226
  v_mfma_f32_16x16x32_bf16 v[152:155], a[96:99], a[16:19], v[152:155]
  v_xor_b32 v227, 0x8000, v227
  v_mfma_f32_16x16x32_bf16 v[220:223], a[192:195], v[184:187], v[220:223]
  s_waitcnt lgkmcnt(2)
  buffer_load_dwordx4 v236, s[20:23], s58 offen offset:0 nt lds
  v_mfma_f32_16x16x32_bf16 v[156:159], a[112:115], a[16:19], v[196:199]
  v_mfma_f32_16x16x32_bf16 v[156:159], a[116:119], a[20:23], v[156:159]
  s_waitcnt lgkmcnt(1)
  buffer_load_dwordx4 v237, s[20:23], s58 offen offset:1024 nt lds
  v_mfma_f32_16x16x32_bf16 v[156:159], a[120:123], a[24:27], v[156:159]
  s_waitcnt lgkmcnt(0)
  v_mfma_f32_16x16x32_bf16 v[156:159], a[124:127], a[28:31], v[156:159]
  buffer_load_dwordx4 v236, s[20:23], s58 offen offset:2048 nt lds
  v_mfma_f32_16x16x32_bf16 v[140:143], a[124:127], a[12:15], v[192:195]
  v_mfma_f32_16x16x32_bf16 v[140:143], a[120:123], a[8:11], v[140:143]
  buffer_load_dwordx4 v237, s[20:23], s58 offen offset:3072 nt lds
  v_mfma_f32_16x16x32_bf16 v[140:143], a[116:119], a[4:7], v[140:143]
  v_mfma_f32_16x16x32_bf16 v[140:143], a[112:115], a[0:3], v[140:143]
L_peel_end:
  v_exp_f32 v128, v128
.p2align 3
L_loop:
  v_mfma_f32_16x16x32_bf16 v[64:67], v[160:163], a[128:131], v[64:67]
  s_waitcnt vmcnt(8)
  v_exp_f32 v129, v129
  v_mfma_f32_16x16x32_bf16 v[64:67], v[168:171], a[132:135], v[64:67]
  s_barrier
  v_exp_f32 v130, v130
  v_mfma_f32_16x16x32_bf16 v[96:99], v[184:187], a[132:135], v[96:99]
  s_add_u32 s30, s30, 16384
  v_cvt_pk_bf16_f32 v128, v128, v129
  v_add_f32 v244, v244, v216
  v_mfma_f32_16x16x32_bf16 v[96:99], v[176:179], a[128:131], v[96:99]
  s_add_u32 m0, s34, 0
  v_exp_f32 v131, v131
  v_mfma_f32_16x16x32_bf16 v[100:103], v[176:179], a[136:139], v[100:103]
  v_exp_f32 v132, v132
  v_mfma_f32_16x16x32_bf16 v[100:103], v[184:187], a[140:143], v[100:103]
  buffer_load_dwordx4 v236, s[16:19], s30 offen offset:0 nt lds
  v_mfma_f32_16x16x32_bf16 v[68:71], v[168:171], a[140:143], v[68:71]
  ds_read_b64_tr_b16 a[128:129], v228 offset:16384
  v_cvt_pk_bf16_f32 v129, v130, v131
  v_mfma_f32_16x16x32_bf16 v[68:71], v[160:163], a[136:139], v[68:71]
  v_exp_f32 v133, v133
  v_mfma_f32_16x16x32_bf16 v[72:75], v[160:163], a[144:147], v[72:75]
  v_exp_f32 v134, v134
  v_mfma_f32_16x16x32_bf16 v[72:75], v[168:171], a[148:151], v[72:75]
  ds_read_b64_tr_b16 a[130:131], v228 offset:20480
  v_cvt_pk_bf16_f32 v130, v132, v133
  v_mfma_f32_16x16x32_bf16 v[104:107], v[184:187], a[148:151], v[104:107]
  v_exp_f32 v135, v135
  v_mfma_f32_16x16x32_bf16 v[104:107], v[176:179], a[144:147], v[104:107]
  v_exp_f32 v136, v136
  v_mfma_f32_16x16x32_bf16 v[108:111], v[176:179], a[152:155], v[108:111]
  ds_read_b64_tr_b16 a[132:133], v228 offset:24576
  v_cvt_pk_bf16_f32 v131, v134, v135
  v_mfma_f32_16x16x32_bf16 v[108:111], v[184:187], a[156:159], v[108:111]
  ds_read_b64_tr_b16 a[134:135], v228 offset:28672
  v_add_f32 v245, v245, v220
  v_mfma_f32_16x16x32_bf16 v[208:211], a[192:195], v[128:131], 0
  buffer_load_dwordx4 v237, s[16:19], s30 offen offset:1024 nt lds
  v_mfma_f32_16x16x32_bf16 v[76:79], v[168:171], a[156:159], v[76:79]
  v_exp_f32 v137, v137
  v_mfma_f32_16x16x32_bf16 v[76:79], v[160:163], a[152:155], v[76:79]
  ds_read_b64_tr_b16 a[136:137], v229 offset:16384
  v_mfma_f32_16x16x32_bf16 v[80:83], v[160:163], a[160:163], v[80:83]
  v_exp_f32 v138, v138
  v_mfma_f32_16x16x32_bf16 v[80:83], v[168:171], a[164:167], v[80:83]
  ds_read_b64_tr_b16 a[138:139], v229 offset:20480
  v_cvt_pk_bf16_f32 v136, v136, v137
  v_mfma_f32_16x16x32_bf16 v[112:115], v[184:187], a[164:167], v[112:115]
  ds_read_b64_tr_b16 a[140:141], v229 offset:24576
  v_mfma_f32_16x16x32_bf16 v[112:115], v[176:179], a[160:163], v[112:115]
  buffer_load_dwordx4 v238, s[16:19], s30 offen offset:2048 nt lds
  v_mfma_f32_16x16x32_bf16 v[116:119], v[176:179], a[168:171], v[116:119]
  v_exp_f32 v139, v139
  v_mfma_f32_16x16x32_bf16 v[116:119], v[184:187], a[172:175], v[116:119]
  v_exp_f32 v140, v140
  v_mfma_f32_16x16x32_bf16 v[84:87], v[168:171], a[172:175], v[84:87]
  ds_read_b64_tr_b16 a[142:143], v229 offset:28672
  v_cvt_pk_bf16_f32 v137, v138, v139
  v_mfma_f32_16x16x32_bf16 v[84:87], v[160:163], a[168:171], v[84:87]
  ds_read_b64_tr_b16 a[144:145], v230 offset:16384
  v_mfma_f32_16x16x32_bf16 v[88:91], v[160:163], a[176:179], v[88:91]
  v_exp_f32 v141, v141
  v_mfma_f32_16x16x32_bf16 v[88:91], v[168:171], a[180:183], v[88:91]
  v_exp_f32 v142, v142
  v_mfma_f32_16x16x32_bf16 v[120:123], v[184:187], a[180:183], v[120:123]
  ds_read_b64_tr_b16 a[146:147], v230 offset:20480
  v_cvt_pk_bf16_f32 v138, v140, v141
  v_mfma_f32_16x16x32_bf16 v[120:123], v[176:179], a[176:179], v[120:123]
  v_exp_f32 v143, v143
  v_mfma_f32_16x16x32_bf16 v[124:127], v[176:179], a[184:187], v[124:127]
  v_exp_f32 v144, v144
  v_mfma_f32_16x16x32_bf16 v[124:127], v[184:187], a[188:191], v[124:127]
  buffer_load_dwordx4 v239, s[16:19], s30 offen offset:3072 nt lds
  v_mfma_f32_16x16x32_bf16 v[92:95], v[168:171], a[188:191], v[92:95]
  ds_read_b64_tr_b16 a[148:149], v230 offset:24576
  v_cvt_pk_bf16_f32 v139, v142, v143
  v_mfma_f32_16x16x32_bf16 v[92:95], v[160:163], a[184:187], v[92:95]
  ds_read_b64_tr_b16 a[150:151], v230 offset:28672
  v_mfma_f32_16x16x32_bf16 v[208:211], a[192:195], v[136:139], v[208:211]
  v_exp_f32 v145, v145
  v_mfma_f32_16x16x32_bf16 v[160:163], a[64:67], a[32:35], v[200:203]
  v_exp_f32 v146, v146
  v_mfma_f32_16x16x32_bf16 v[160:163], a[68:71], a[36:39], v[160:163]
  v_cvt_pk_bf16_f32 v144, v144, v145
  v_mfma_f32_16x16x32_bf16 v[160:163], a[72:75], a[40:43], v[160:163]
  v_exp_f32 v147, v147
  v_mfma_f32_16x16x32_bf16 v[160:163], a[76:79], a[44:47], v[160:163]
  ds_read_b64_tr_b16 a[152:153], v231 offset:16384
  v_mfma_f32_16x16x32_bf16 v[176:179], a[76:79], a[60:63], v[204:207]
  v_exp_f32 v148, v148
  v_mfma_f32_16x16x32_bf16 v[176:179], a[72:75], a[56:59], v[176:179]
  ds_read_b64_tr_b16 a[154:155], v231 offset:20480
  v_cvt_pk_bf16_f32 v145, v146, v147
  v_mfma_f32_16x16x32_bf16 v[176:179], a[68:71], a[52:55], v[176:179]
  v_exp_f32 v149, v149
  v_mfma_f32_16x16x32_bf16 v[176:179], a[64:67], a[48:51], v[176:179]
  v_exp_f32 v150, v150
  v_mfma_f32_16x16x32_bf16 v[180:183], a[80:83], a[48:51], v[204:207]
  ds_read_b64_tr_b16 a[156:157], v231 offset:24576
  v_cvt_pk_bf16_f32 v146, v148, v149
  v_mfma_f32_16x16x32_bf16 v[180:183], a[84:87], a[52:55], v[180:183]
  v_exp_f32 v151, v151
  v_mfma_f32_16x16x32_bf16 v[180:183], a[88:91], a[56:59], v[180:183]
  v_exp_f32 v152, v152
  v_mfma_f32_16x16x32_bf16 v[180:183], a[92:95], a[60:63], v[180:183]
  ds_read_b64_tr_b16 a[158:159], v231 offset:28672
  v_cvt_pk_bf16_f32 v147, v150, v151
  v_mfma_f32_16x16x32_bf16 v[164:167], a[92:95], a[44:47], v[200:203]
  v_exp_f32 v153, v153
  v_mfma_f32_16x16x32_bf16 v[164:167], a[88:91], a[40:43], v[164:167]
  v_exp_f32 v154, v154
  v_mfma_f32_16x16x32_bf16 v[164:167], a[84:87], a[36:39], v[164:167]
  ds_read_b64_tr_b16 a[160:161], v232 offset:16384
  v_cvt_pk_bf16_f32 v152, v152, v153
  v_mfma_f32_16x16x32_bf16 v[164:167], a[80:83], a[32:35], v[164:167]
  v_exp_f32 v155, v155
  v_mfma_f32_16x16x32_bf16 v[212:215], a[192:195], v[144:147], 0
  v_exp_f32 v156, v156
  v_mfma_f32_16x16x32_bf16 v[168:171], a[96:99], a[32:35], v[200:203]
  ds_read_b64_tr_b16 a[162:163], v232 offset:20480
  v_cvt_pk_bf16_f32 v153, v154, v155
  v_mfma_f32_16x16x32_bf16 v[168:171], a[100:103], a[36:39], v[168:171]
  v_exp_f32 v157, v157
  v_mfma_f32_16x16x32_bf16 v[168:171], a[104:107], a[40:43], v[168:171]
  v_exp_f32 v158, v158
  v_mfma_f32_16x16x32_bf16 v[168:171], a[108:111], a[44:47], v[168:171]
  ds_read_b64_tr_b16 a[164:165], v232 offset:24576
  v_cvt_pk_bf16_f32 v154, v156, v157
  v_mfma_f32_16x16x32_bf16 v[184:187], a[108:111], a[60:63], v[204:207]
  v_exp_f32 v159, v159
  v_mfma_f32_16x16x32_bf16 v[184:187], a[104:107], a[56:59], v[184:187]
  ds_read_b64_tr_b16 a[166:167], v232 offset:28672
  v_cvt_pk_bf16_f32 v155, v158, v159
  v_mfma_f32_16x16x32_bf16 v[184:187], a[100:103], a[52:55], v[184:187]
  ds_read_b64_tr_b16 a[168:169], v233 offset:16384
  v_mfma_f32_16x16x32_bf16 v[184:187], a[96:99], a[48:51], v[184:187]
  ds_read_b64_tr_b16 a[170:171], v233 offset:20480
  v_mfma_f32_16x16x32_bf16 v[212:215], a[192:195], v[152:155], v[212:215]
  ds_read_b64_tr_b16 a[172:173], v233 offset:24576
  v_mfma_f32_16x16x32_bf16 v[188:191], a[112:115], a[48:51], v[204:207]
  ds_read_b64_tr_b16 a[174:175], v233 offset:28672
  v_mfma_f32_16x16x32_bf16 v[188:191], a[116:119], a[52:55], v[188:191]
  ds_read_b64_tr_b16 a[176:177], v234 offset:16384
  v_mfma_f32_16x16x32_bf16 v[188:191], a[120:123], a[56:59], v[188:191]
  ds_read_b64_tr_b16 a[178:179], v234 offset:20480
  v_mfma_f32_16x16x32_bf16 v[188:191], a[124:127], a[60:63], v[188:191]
  ds_read_b64_tr_b16 a[180:181], v234 offset:24576
  v_max_f32 v246, v208, v212
  v_mfma_f32_16x16x32_bf16 v[172:175], a[124:127], a[44:47], v[200:203]
  ds_read_b64_tr_b16 a[182:183], v234 offset:28672
  v_cmp_lt_f32 vcc, 0x49800000, v246
  v_mfma_f32_16x16x32_bf16 v[172:175], a[120:123], a[40:43], v[172:175]
  ds_read_b64_tr_b16 a[184:185], v235 offset:16384
  v_mfma_f32_16x16x32_bf16 v[172:175], a[116:119], a[36:39], v[172:175]
  s_waitcnt lgkmcnt(7)
  v_mfma_f32_16x16x32_bf16 v[172:175], a[112:115], a[32:35], v[172:175]
  s_cbranch_vccnz L_slow_2
L_slow_2_ret:
  v_exp_f32 v160, v160
  v_mfma_f32_16x16x32_bf16 v[0:3], v[128:131], a[128:131], v[0:3]
  v_exp_f32 v161, v161
  v_mfma_f32_16x16x32_bf16 v[0:3], v[136:139], a[132:135], v[0:3]
  v_exp_f32 v162, v162
  v_mfma_f32_16x16x32_bf16 v[32:35], v[152:155], a[132:135], v[32:35]
  ds_read_b64_tr_b16 a[186:187], v235 offset:20480
  v_cvt_pk_bf16_f32 v160, v160, v161
  v_mfma_f32_16x16x32_bf16 v[32:35], v[144:147], a[128:131], v[32:35]
  v_exp_f32 v163, v163
  v_mfma_f32_16x16x32_bf16 v[36:39], v[144:147], a[136:139], v[36:39]
  v_exp_f32 v164, v164
  v_mfma_f32_16x16x32_bf16 v[36:39], v[152:155], a[140:143], v[36:39]
  s_add_u32 s58, s58, 16384
  ds_read_b64_tr_b16 a[188:189], v235 offset:24576
  v_cvt_pk_bf16_f32 v161, v162, v163
  v_mfma_f32_16x16x32_bf16 v[4:7], v[136:139], a[140:143], v[4:7]
  v_exp_f32 v165, v165
  v_mfma_f32_16x16x32_bf16 v[4:7], v[128:131], a[136:139], v[4:7]
  s_add_u32 m0, s59, 81920
  ds_read_b64_tr_b16 a[190:191], v235 offset:28672
  v_add_f32 v242, v242, v208
  v_mfma_f32_16x16x32_bf16 v[8:11], v[128:131], a[144:147], v[8:11]
  v_exp_f32 v166, v166
  v_mfma_f32_16x16x32_bf16 v[8:11], v[136:139], a[148:151], v[8:11]
  ds_read_b128 a[64:67], v224 offset:0
  v_cvt_pk_bf16_f32 v162, v164, v165
  v_mfma_f32_16x16x32_bf16 v[40:43], v[152:155], a[148:151], v[40:43]
  buffer_load_dwordx4 v236, s[20:23], s58 offen offset:0 nt lds
  v_mfma_f32_16x16x32_bf16 v[40:43], v[144:147], a[144:147], v[40:43]
  v_exp_f32 v167, v167
  v_mfma_f32_16x16x32_bf16 v[44:47], v[144:147], a[152:155], v[44:47]
  ds_read_b128 a[68:71], v225 offset:0
  v_add_f32 v243, v243, v212
  v_mfma_f32_16x16x32_bf16 v[44:47], v[152:155], a[156:159], v[44:47]
  v_exp_f32 v168, v168
  v_mfma_f32_16x16x32_bf16 v[12:15], v[136:139], a[156:159], v[12:15]
  ds_read_b128 a[72:75], v226 offset:0
  v_cvt_pk_bf16_f32 v163, v166, v167
  v_mfma_f32_16x16x32_bf16 v[12:15], v[128:131], a[152:155], v[12:15]
  v_exp_f32 v169, v169
  v_mfma_f32_16x16x32_bf16 v[216:219], a[192:195], v[160:163], 0
  buffer_load_dwordx4 v237, s[20:23], s58 offen offset:1024 nt lds
  v_mfma_f32_16x16x32_bf16 v[16:19], v[128:131], a[160:163], v[16:19]
  ds_read_b128 a[76:79], v227 offset:0
  v_mfma_f32_16x16x32_bf16 v[16:19], v[136:139], a[164:167], v[16:19]
  v_exp_f32 v170, v170
  v_mfma_f32_16x16x32_bf16 v[48:51], v[152:155], a[164:167], v[48:51]
  ds_read_b128 a[80:83], v224 offset:4096
  v_cvt_pk_bf16_f32 v168, v168, v169
  v_mfma_f32_16x16x32_bf16 v[48:51], v[144:147], a[160:163], v[48:51]
  v_exp_f32 v171, v171
  v_mfma_f32_16x16x32_bf16 v[52:55], v[144:147], a[168:171], v[52:55]
  s_waitcnt lgkmcnt(3)
  v_exp_f32 v172, v172
  v_mfma_f32_16x16x32_bf16 v[52:55], v[152:155], a[172:175], v[52:55]
  ds_read_b128 a[84:87], v225 offset:4096
  v_cvt_pk_bf16_f32 v169, v170, v171
  v_mfma_f32_16x16x32_bf16 v[20:23], v[136:139], a[172:175], v[20:23]
  ds_read_b128 a[88:91], v226 offset:4096
  v_mfma_f32_16x16x32_bf16 v[20:23], v[128:131], a[168:171], v[20:23]
  buffer_load_dwordx4 v236, s[20:23], s58 offen offset:2048 nt lds
  v_mfma_f32_16x16x32_bf16 v[24:27], v[128:131], a[176:179], v[24:27]
  v_exp_f32 v173, v173
  v_mfma_f32_16x16x32_bf16 v[24:27], v[136:139], a[180:183], v[24:27]
  ds_read_b128 a[92:95], v227 offset:4096
  v_mfma_f32_16x16x32_bf16 v[56:59], v[152:155], a[180:183], v[56:59]
  v_exp_f32 v174, v174
  v_mfma_f32_16x16x32_bf16 v[56:59], v[144:147], a[176:179], v[56:59]
  ds_read_b128 a[96:99], v224 offset:8192
  v_cvt_pk_bf16_f32 v170, v172, v173
  v_mfma_f32_16x16x32_bf16 v[60:63], v[144:147], a[184:187], v[60:63]
  v_exp_f32 v175, v175
  v_mfma_f32_16x16x32_bf16 v[60:63], v[152:155], a[188:191], v[60:63]
  v_exp_f32 v176, v176
  v_mfma_f32_16x16x32_bf16 v[28:31], v[136:139], a[188:191], v[28:31]
  buffer_load_dwordx4 v237, s[20:23], s58 offen offset:3072 nt lds
  v_mfma_f32_16x16x32_bf16 v[28:31], v[128:131], a[184:187], v[28:31]
  s_xor_b32 s59, s59, 0x8000
  v_cvt_pk_bf16_f32 v171, v174, v175
  s_nop 1
  v_mfma_f32_16x16x32_bf16 v[216:219], a[192:195], v[168:171], v[216:219]
  v_mfma_f32_16x16x32_bf16 v[128:131], a[64:67], a[0:3], v[192:195]
  v_exp_f32 v177, v177
  v_mfma_f32_16x16x32_bf16 v[128:131], a[68:71], a[4:7], v[128:131]
  s_waitcnt lgkmcnt(1)
  v_exp_f32 v178, v178
  v_mfma_f32_16x16x32_bf16 v[128:131], a[72:75], a[8:11], v[128:131]
  ds_read_b128 a[100:103], v225 offset:8192
  v_cvt_pk_bf16_f32 v176, v176, v177
  v_mfma_f32_16x16x32_bf16 v[128:131], a[76:79], a[12:15], v[128:131]
  v_exp_f32 v179, v179
  v_mfma_f32_16x16x32_bf16 v[144:147], a[76:79], a[28:31], v[196:199]
  v_exp_f32 v180, v180
  v_mfma_f32_16x16x32_bf16 v[144:147], a[72:75], a[24:27], v[144:147]
  ds_read_b128 a[104:107], v226 offset:8192
  v_cvt_pk_bf16_f32 v177, v178, v179
  v_mfma_f32_16x16x32_bf16 v[144:147], a[68:71], a[20:23], v[144:147]
  v_exp_f32 v181, v181
  v_mfma_f32_16x16x32_bf16 v[144:147], a[64:67], a[16:19], v[144:147]
  v_exp_f32 v182, v182
  v_mfma_f32_16x16x32_bf16 v[148:151], a[80:83], a[16:19], v[196:199]
  ds_read_b128 a[108:111], v227 offset:8192
  v_cvt_pk_bf16_f32 v178, v180, v181
  v_mfma_f32_16x16x32_bf16 v[148:151], a[84:87], a[20:23], v[148:151]
  v_exp_f32 v183, v183
  v_mfma_f32_16x16x32_bf16 v[148:151], a[88:91], a[24:27], v[148:151]
  v_exp_f32 v184, v184
  v_mfma_f32_16x16x32_bf16 v[148:151], a[92:95], a[28:31], v[148:151]
  ds_read_b128 a[112:115], v224 offset:12288
  v_cvt_pk_bf16_f32 v179, v182, v183
  v_mfma_f32_16x16x32_bf16 v[132:135], a[92:95], a[12:15], v[192:195]
  v_exp_f32 v185, v185
  v_mfma_f32_16x16x32_bf16 v[132:135], a[88:91], a[8:11], v[132:135]
  v_exp_f32 v186, v186
  v_mfma_f32_16x16x32_bf16 v[132:135], a[84:87], a[4:7], v[132:135]
  ds_read_b128 a[116:119], v225 offset:12288
  v_cvt_pk_bf16_f32 v184, v184, v185
  v_mfma_f32_16x16x32_bf16 v[132:135], a[80:83], a[0:3], v[132:135]
  v_exp_f32 v187, v187
  v_mfma_f32_16x16x32_bf16 v[220:223], a[192:195], v[176:179], 0
  s_waitcnt lgkmcnt(3)
  v_exp_f32 v188, v188
  v_mfma_f32_16x16x32_bf16 v[136:139], a[96:99], a[0:3], v[192:195]
  ds_read_b128 a[120:123], v226 offset:12288
  v_cvt_pk_bf16_f32 v185, v186, v187
  v_mfma_f32_16x16x32_bf16 v[136:139], a[100:103], a[4:7], v[136:139]
  v_exp_f32 v189, v189
  v_mfma_f32_16x16x32_bf16 v[136:139], a[104:107], a[8:11], v[136:139]
  s_waitcnt lgkmcnt(3)
  v_exp_f32 v190, v190
  v_mfma_f32_16x16x32_bf16 v[136:139], a[108:111], a[12:15], v[136:139]
  ds_read_b128 a[124:127], v227 offset:12288
  v_cvt_pk_bf16_f32 v186, v188, v189
  v_mfma_f32_16x16x32_bf16 v[152:155], a[108:111], a[28:31], v[196:199]
  v_exp_f32 v191, v191
  v_mfma_f32_16x16x32_bf16 v[152:155], a[104:107], a[24:27], v[152:155]
  v_cvt_pk_bf16_f32 v187, v190, v191
  v_xor_b32 v228, 0x8000, v228
  v_mfma_f32_16x16x32_bf16 v[152:155], a[100:103], a[20:23], v[152:155]
  v_xor_b32 v229, 0x8000, v229
  v_xor_b32 v230, 0x8000, v230
  v_mfma_f32_16x16x32_bf16 v[152:155], a[96:99], a[16:19], v[152:155]
  v_xor_b32 v231, 0x8000, v231
  v_xor_b32 v232, 0x8000, v232
  v_mfma_f32_16x16x32_bf16 v[220:223], a[192:195], v[184:187], v[220:223]
  s_waitcnt lgkmcnt(2)
  v_xor_b32 v233, 0x8000, v233
  v_xor_b32 v234, 0x8000, v234
  v_mfma_f32_16x16x32_bf16 v[156:159], a[112:115], a[16:19], v[196:199]
  v_xor_b32 v235, 0x8000, v235
  v_mfma_f32_16x16x32_bf16 v[156:159], a[116:119], a[20:23], v[156:159]
  s_waitcnt lgkmcnt(1)
  v_mfma_f32_16x16x32_bf16 v[156:159], a[120:123], a[24:27], v[156:159]
  s_waitcnt lgkmcnt(0)
  v_mfma_f32_16x16x32_bf16 v[156:159], a[124:127], a[28:31], v[156:159]
  v_mfma_f32_16x16x32_bf16 v[140:143], a[124:127], a[12:15], v[192:195]
  v_max_f32 v246, v216, v220
  v_cmp_lt_f32 vcc, 0x49800000, v246
  v_mfma_f32_16x16x32_bf16 v[140:143], a[120:123], a[8:11], v[140:143]
  v_mfma_f32_16x16x32_bf16 v[140:143], a[116:119], a[4:7], v[140:143]
  v_mfma_f32_16x16x32_bf16 v[140:143], a[112:115], a[0:3], v[140:143]
  s_cbranch_vccnz L_slow_3
L_slow_3_ret:
  v_exp_f32 v128, v128
  v_mfma_f32_16x16x32_bf16 v[64:67], v[160:163], a[128:131], v[64:67]
  s_waitcnt vmcnt(8)
  v_exp_f32 v129, v129
  v_mfma_f32_16x16x32_bf16 v[64:67], v[168:171], a[132:135], v[64:67]
  s_barrier
  v_exp_f32 v130, v130
  v_mfma_f32_16x16x32_bf16 v[96:99], v[184:187], a[132:135], v[96:99]
  s_add_u32 s30, s30, 16384
  v_cvt_pk_bf16_f32 v128, v128, v129
  v_add_f32 v244, v244, v216
  v_mfma_f32_16x16x32_bf16 v[96:99], v[176:179], a[128:131], v[96:99]
  s_add_u32 m0, s34, 16384
  v_exp_f32 v131, v131
  v_mfma_f32_16x16x32_bf16 v[100:103], v[176:179], a[136:139], v[100:103]
  v_exp_f32 v132, v132
  v_mfma_f32_16x16x32_bf16 v[100:103], v[184:187], a[140:143], v[100:103]
  buffer_load_dwordx4 v236, s[16:19], s30 offen offset:0 nt lds
  v_mfma_f32_16x16x32_bf16 v[68:71], v[168:171], a[140:143], v[68:71]
  ds_read_b64_tr_b16 a[128:129], v228 offset:0
  v_cvt_pk_bf16_f32 v129, v130, v131
  v_mfma_f32_16x16x32_bf16 v[68:71], v[160:163], a[136:139], v[68:71]
  v_exp_f32 v133, v133
  v_mfma_f32_16x16x32_bf16 v[72:75], v[160:163], a[144:147], v[72:75]
  v_exp_f32 v134, v134
  v_mfma_f32_16x16x32_bf16 v[72:75], v[168:171], a[148:151], v[72:75]
  ds_read_b64_tr_b16 a[130:131], v228 offset:4096
  v_cvt_pk_bf16_f32 v130, v132, v133
  v_mfma_f32_16x16x32_bf16 v[104:107], v[184:187], a[148:151], v[104:107]
  v_exp_f32 v135, v135
  v_mfma_f32_16x16x32_bf16 v[104:107], v[176:179], a[144:147], v[104:107]
  v_exp_f32 v136, v136
  v_mfma_f32_16x16x32_bf16 v[108:111], v[176:179], a[152:155], v[108:111]
  ds_read_b64_tr_b16 a[132:133], v228 offset:8192
  v_cvt_pk_bf16_f32 v131, v134, v135
  v_mfma_f32_16x16x32_bf16 v[108:111], v[184:187], a[156:159], v[108:111]
  ds_read_b64_tr_b16 a[134:135], v228 offset:12288
  v_add_f32 v245, v245, v220
  v_mfma_f32_16x16x32_bf16 v[208:211], a[192:195], v[128:131], 0
  buffer_load_dwordx4 v237, s[16:19], s30 offen offset:1024 nt lds
  v_mfma_f32_16x16x32_bf16 v[76:79], v[168:171], a[156:159], v[76:79]
  v_exp_f32 v137, v137
  v_mfma_f32_16x16x32_bf16 v[76:79], v[160:163], a[152:155], v[76:79]
  ds_read_b64_tr_b16 a[136:137], v229 offset:0
  v_mfma_f32_16x16x32_bf16 v[80:83], v[160:163], a[160:163], v[80:83]
  v_exp_f32 v138, v138
  v_mfma_f32_16x16x32_bf16 v[80:83], v[168:171], a[164:167], v[80:83]
  ds_read_b64_tr_b16 a[138:139], v229 offset:4096
  v_cvt_pk_bf16_f32 v136, v136, v137
  v_mfma_f32_16x16x32_bf16 v[112:115], v[184:187], a[164:167], v[112:115]
  ds_read_b64_tr_b16 a[140:141], v229 offset:8192
  v_mfma_f32_16x16x32_bf16 v[112:115], v[176:179], a[160:163], v[112:115]
  buffer_load_dwordx4 v238, s[16:19], s30 offen offset:2048 nt lds
  v_mfma_f32_16x16x32_bf16 v[116:119], v[176:179], a[168:171], v[116:119]
  v_exp_f32 v139, v139
  v_mfma_f32_16x16x32_bf16 v[116:119], v[184:187], a[172:175], v[116:119]
  v_exp_f32 v140, v140
  v_mfma_f32_16x16x32_bf16 v[84:87], v[168:171], a[172:175], v[84:87]
  ds_read_b64_tr_b16 a[142:143], v229 offset:12288
  v_cvt_pk_bf16_f32 v137, v138, v139
  v_mfma_f32_16x16x32_bf16 v[84:87], v[160:163], a[168:171], v[84:87]
  ds_read_b64_tr_b16 a[144:145], v230 offset:0
  v_mfma_f32_16x16x32_bf16 v[88:91], v[160:163], a[176:179], v[88:91]
  v_exp_f32 v141, v141
  v_mfma_f32_16x16x32_bf16 v[88:91], v[168:171], a[180:183], v[88:91]
  v_exp_f32 v142, v142
  v_mfma_f32_16x16x32_bf16 v[120:123], v[184:187], a[180:183], v[120:123]
  ds_read_b64_tr_b16 a[146:147], v230 offset:4096
  v_cvt_pk_bf16_f32 v138, v140, v141
  v_mfma_f32_16x16x32_bf16 v[120:123], v[176:179], a[176:179], v[120:123]
  v_exp_f32 v143, v143
  v_mfma_f32_16x16x32_bf16 v[124:127], v[176:179], a[184:187], v[124:127]
  v_exp_f32 v144, v144
  v_mfma_f32_16x16x32_bf16 v[124:127], v[184:187], a[188:191], v[124:127]
  buffer_load_dwordx4 v239, s[16:19], s30 offen offset:3072 nt lds
  v_mfma_f32_16x16x32_bf16 v[92:95], v[168:171], a[188:191], v[92:95]
  s_xor_b32 s34, s34, 0x8000
  ds_read_b64_tr_b16 a[148:149], v230 offset:8192
  v_cvt_pk_bf16_f32 v139, v142, v143
  v_mfma_f32_16x16x32_bf16 v[92:95], v[160:163], a[184:187], v[92:95]
  ds_read_b64_tr_b16 a[150:151], v230 offset:12288
  v_mfma_f32_16x16x32_bf16 v[208:211], a[192:195], v[136:139], v[208:211]
  v_exp_f32 v145, v145
  v_mfma_f32_16x16x32_bf16 v[160:163], a[64:67], a[32:35], v[200:203]
  v_exp_f32 v146, v146
  v_mfma_f32_16x16x32_bf16 v[160:163], a[68:71], a[36:39], v[160:163]
  v_cvt_pk_bf16_f32 v144, v144, v145
  v_mfma_f32_16x16x32_bf16 v[160:163], a[72:75], a[40:43], v[160:163]
  v_exp_f32 v147, v147
  v_mfma_f32_16x16x32_bf16 v[160:163], a[76:79], a[44:47], v[160:163]
  ds_read_b64_tr_b16 a[152:153], v231 offset:0
  v_mfma_f32_16x16x32_bf16 v[176:179], a[76:79], a[60:63], v[204:207]
  v_exp_f32 v148, v148
  v_mfma_f32_16x16x32_bf16 v[176:179], a[72:75], a[56:59], v[176:179]
  ds_read_b64_tr_b16 a[154:155], v231 offset:4096
  v_cvt_pk_bf16_f32 v145, v146, v147
  v_mfma_f32_16x16x32_bf16 v[176:179], a[68:71], a[52:55], v[176:179]
  v_exp_f32 v149, v149
  v_mfma_f32_16x16x32_bf16 v[176:179], a[64:67], a[48:51], v[176:179]
  v_exp_f32 v150, v150
  v_mfma_f32_16x16x32_bf16 v[180:183], a[80:83], a[48:51], v[204:207]
  ds_read_b64_tr_b16 a[156:157], v231 offset:8192
  v_cvt_pk_bf16_f32 v146, v148, v149
  v_mfma_f32_16x16x32_bf16 v[180:183], a[84:87], a[52:55], v[180:183]
  v_exp_f32 v151, v151
  v_mfma_f32_16x16x32_bf16 v[180:183], a[88:91], a[56:59], v[180:183]
  v_exp_f32 v152, v152
  v_mfma_f32_16x16x32_bf16 v[180:183], a[92:95], a[60:63], v[180:183]
  ds_read_b64_tr_b16 a[158:159], v231 offset:12288
  v_cvt_pk_bf16_f32 v147, v150, v151
  v_mfma_f32_16x16x32_bf16 v[164:167], a[92:95], a[44:47], v[200:203]
  v_exp_f32 v153, v153
  v_mfma_f32_16x16x32_bf16 v[164:167], a[88:91], a[40:43], v[164:167]
  v_exp_f32 v154, v154
  v_mfma_f32_16x16x32_bf16 v[164:167], a[84:87], a[36:39], v[164:167]
  ds_read_b64_tr_b16 a[160:161], v232 offset:0
  v_cvt_pk_bf16_f32 v152, v152, v153
  v_mfma_f32_16x16x32_bf16 v[164:167], a[80:83], a[32:35], v[164:167]
  v_exp_f32 v155, v155
  v_mfma_f32_16x16x32_bf16 v[212:215], a[192:195], v[144:147], 0
  v_exp_f32 v156, v156
  v_mfma_f32_16x16x32_bf16 v[168:171], a[96:99], a[32:35], v[200:203]
  ds_read_b64_tr_b16 a[162:163], v232 offset:4096
  v_cvt_pk_bf16_f32 v153, v154, v155
  v_mfma_f32_16x16x32_bf16 v[168:171], a[100:103], a[36:39], v[168:171]
  v_exp_f32 v157, v157
  v_mfma_f32_16x16x32_bf16 v[168:171], a[104:107], a[40:43], v[168:171]
  v_exp_f32 v158, v158
  v_mfma_f32_16x16x32_bf16 v[168:171], a[108:111], a[44:47], v[168:171]
  ds_read_b64_tr_b16 a[164:165], v232 offset:8192
  v_cvt_pk_bf16_f32 v154, v156, v157
  v_mfma_f32_16x16x32_bf16 v[184:187], a[108:111], a[60:63], v[204:207]
  v_exp_f32 v159, v159
  v_mfma_f32_16x16x32_bf16 v[184:187], a[104:107], a[56:59], v[184:187]
  ds_read_b64_tr_b16 a[166:167], v232 offset:12288
  v_cvt_pk_bf16_f32 v155, v158, v159
  v_mfma_f32_16x16x32_bf16 v[184:187], a[100:103], a[52:55], v[184:187]
  ds_read_b64_tr_b16 a[168:169], v233 offset:0
  v_mfma_f32_16x16x32_bf16 v[184:187], a[96:99], a[48:51], v[184:187]
  ds_read_b64_tr_b16 a[170:171], v233 offset:4096
  v_mfma_f32_16x16x32_bf16 v[212:215], a[192:195], v[152:155], v[212:215]
  ds_read_b64_tr_b16 a[172:173], v233 offset:8192
  v_mfma_f32_16x16x32_bf16 v[188:191], a[112:115], a[48:51], v[204:207]
  ds_read_b64_tr_b16 a[174:175], v233 offset:12288
  v_mfma_f32_16x16x32_bf16 v[188:191], a[116:119], a[52:55], v[188:191]
  ds_read_b64_tr_b16 a[176:177], v234 offset:0
  v_mfma_f32_16x16x32_bf16 v[188:191], a[120:123], a[56:59], v[188:191]
  ds_read_b64_tr_b16 a[178:179], v234 offset:4096
  v_mfma_f32_16x16x32_bf16 v[188:191], a[124:127], a[60:63], v[188:191]
  ds_read_b64_tr_b16 a[180:181], v234 offset:8192
  v_max_f32 v246, v208, v212
  v_mfma_f32_16x16x32_bf16 v[172:175], a[124:127], a[44:47], v[200:203]
  ds_read_b64_tr_b16 a[182:183], v234 offset:12288
  v_cmp_lt_f32 vcc, 0x49800000, v246
  v_mfma_f32_16x16x32_bf16 v[172:175], a[120:123], a[40:43], v[172:175]
  ds_read_b64_tr_b16 a[184:185], v235 offset:0
  v_mfma_f32_16x16x32_bf16 v[172:175], a[116:119], a[36:39], v[172:175]
  s_waitcnt lgkmcnt(7)
  v_mfma_f32_16x16x32_bf16 v[172:175], a[112:115], a[32:35], v[172:175]
  s_cbranch_vccnz L_slow_0
L_slow_0_ret:
  v_exp_f32 v160, v160
  v_mfma_f32_16x16x32_bf16 v[0:3], v[128:131], a[128:131], v[0:3]
  v_exp_f32 v161, v161
  v_mfma_f32_16x16x32_bf16 v[0:3], v[136:139], a[132:135], v[0:3]
  v_exp_f32 v162, v162
  v_mfma_f32_16x16x32_bf16 v[32:35], v[152:155], a[132:135], v[32:35]
  ds_read_b64_tr_b16 a[186:187], v235 offset:4096
  v_cvt_pk_bf16_f32 v160, v160, v161
  v_mfma_f32_16x16x32_bf16 v[32:35], v[144:147], a[128:131], v[32:35]
  v_exp_f32 v163, v163
  v_mfma_f32_16x16x32_bf16 v[36:39], v[144:147], a[136:139], v[36:39]
  v_exp_f32 v164, v164
  v_mfma_f32_16x16x32_bf16 v[36:39], v[152:155], a[140:143], v[36:39]
  s_add_u32 s58, s58, 16384
  ds_read_b64_tr_b16 a[188:189], v235 offset:8192
  v_cvt_pk_bf16_f32 v161, v162, v163
  v_mfma_f32_16x16x32_bf16 v[4:7], v[136:139], a[140:143], v[4:7]
  v_exp_f32 v165, v165
  v_mfma_f32_16x16x32_bf16 v[4:7], v[128:131], a[136:139], v[4:7]
  s_add_u32 m0, s59, 65536
  ds_read_b64_tr_b16 a[190:191], v235 offset:12288
  v_add_f32 v242, v242, v208
  v_mfma_f32_16x16x32_bf16 v[8:11], v[128:131], a[144:147], v[8:11]
  v_exp_f32 v166, v166
  v_mfma_f32_16x16x32_bf16 v[8:11], v[136:139], a[148:151], v[8:11]
  ds_read_b128 a[64:67], v224 offset:16384
  v_cvt_pk_bf16_f32 v162, v164, v165
  v_mfma_f32_16x16x32_bf16 v[40:43], v[152:155], a[148:151], v[40:43]
  buffer_load_dwordx4 v236, s[20:23], s58 offen offset:0 nt lds
  v_mfma_f32_16x16x32_bf16 v[40:43], v[144:147], a[144:147], v[40:43]
  v_exp_f32 v167, v167
  v_mfma_f32_16x16x32_bf16 v[44:47], v[144:147], a[152:155], v[44:47]
  ds_read_b128 a[68:71], v225 offset:16384
  v_add_f32 v243, v243, v212
  v_mfma_f32_16x16x32_bf16 v[44:47], v[152:155], a[156:159], v[44:47]
  v_exp_f32 v168, v168
  v_mfma_f32_16x16x32_bf16 v[12:15], v[136:139], a[156:159], v[12:15]
  ds_read_b128 a[72:75], v226 offset:16384
  v_cvt_pk_bf16_f32 v163, v166, v167
  v_mfma_f32_16x16x32_bf16 v[12:15], v[128:131], a[152:155], v[12:15]
  v_exp_f32 v169, v169
  v_mfma_f32_16x16x32_bf16 v[216:219], a[192:195], v[160:163], 0
  buffer_load_dwordx4 v237, s[20:23], s58 offen offset:1024 nt lds
  v_mfma_f32_16x16x32_bf16 v[16:19], v[128:131], a[160:163], v[16:19]
  ds_read_b128 a[76:79], v227 offset:16384
  v_mfma_f32_16x16x32_bf16 v[16:19], v[136:139], a[164:167], v[16:19]
  v_exp_f32 v170, v170
  v_mfma_f32_16x16x32_bf16 v[48:51], v[152:155], a[164:167], v[48:51]
  ds_read_b128 a[80:83], v224 offset:20480
  v_cvt_pk_bf16_f32 v168, v168, v169
  v_mfma_f32_16x16x32_bf16 v[48:51], v[144:147], a[160:163], v[48:51]
  v_exp_f32 v171, v171
  v_mfma_f32_16x16x32_bf16 v[52:55], v[144:147], a[168:171], v[52:55]
  s_waitcnt lgkmcnt(3)
  v_exp_f32 v172, v172
  v_mfma_f32_16x16x32_bf16 v[52:55], v[152:155], a[172:175], v[52:55]
  ds_read_b128 a[84:87], v225 offset:20480
  v_cvt_pk_bf16_f32 v169, v170, v171
  v_mfma_f32_16x16x32_bf16 v[20:23], v[136:139], a[172:175], v[20:23]
  ds_read_b128 a[88:91], v226 offset:20480
  v_mfma_f32_16x16x32_bf16 v[20:23], v[128:131], a[168:171], v[20:23]
  buffer_load_dwordx4 v236, s[20:23], s58 offen offset:2048 nt lds
  v_mfma_f32_16x16x32_bf16 v[24:27], v[128:131], a[176:179], v[24:27]
  v_exp_f32 v173, v173
  v_mfma_f32_16x16x32_bf16 v[24:27], v[136:139], a[180:183], v[24:27]
  ds_read_b128 a[92:95], v227 offset:20480
  v_mfma_f32_16x16x32_bf16 v[56:59], v[152:155], a[180:183], v[56:59]
  v_exp_f32 v174, v174
  v_mfma_f32_16x16x32_bf16 v[56:59], v[144:147], a[176:179], v[56:59]
  ds_read_b128 a[96:99], v224 offset:24576
  v_cvt_pk_bf16_f32 v170, v172, v173
  v_mfma_f32_16x16x32_bf16 v[60:63], v[144:147], a[184:187], v[60:63]
  v_exp_f32 v175, v175
  v_mfma_f32_16x16x32_bf16 v[60:63], v[152:155], a[188:191], v[60:63]
  v_exp_f32 v176, v176
  v_mfma_f32_16x16x32_bf16 v[28:31], v[136:139], a[188:191], v[28:31]
  buffer_load_dwordx4 v237, s[20:23], s58 offen offset:3072 nt lds
  v_mfma_f32_16x16x32_bf16 v[28:31], v[128:131], a[184:187], v[28:31]
  v_cvt_pk_bf16_f32 v171, v174, v175
  s_nop 1
  v_mfma_f32_16x16x32_bf16 v[216:219], a[192:195], v[168:171], v[216:219]
  v_mfma_f32_16x16x32_bf16 v[128:131], a[64:67], a[0:3], v[192:195]
  v_exp_f32 v177, v177
  v_mfma_f32_16x16x32_bf16 v[128:131], a[68:71], a[4:7], v[128:131]
  s_waitcnt lgkmcnt(1)
  v_exp_f32 v178, v178
  v_mfma_f32_16x16x32_bf16 v[128:131], a[72:75], a[8:11], v[128:131]
  ds_read_b128 a[100:103], v225 offset:24576
  v_cvt_pk_bf16_f32 v176, v176, v177
  v_mfma_f32_16x16x32_bf16 v[128:131], a[76:79], a[12:15], v[128:131]
  v_exp_f32 v179, v179
  v_mfma_f32_16x16x32_bf16 v[144:147], a[76:79], a[28:31], v[196:199]
  s_sub_u32 s35, s35, 1
  v_exp_f32 v180, v180
  v_mfma_f32_16x16x32_bf16 v[144:147], a[72:75], a[24:27], v[144:147]
  ds_read_b128 a[104:107], v226 offset:24576
  v_cvt_pk_bf16_f32 v177, v178, v179
  v_mfma_f32_16x16x32_bf16 v[144:147], a[68:71], a[20:23], v[144:147]
  v_exp_f32 v181, v181
  v_mfma_f32_16x16x32_bf16 v[144:147], a[64:67], a[16:19], v[144:147]
  v_exp_f32 v182, v182
  v_mfma_f32_16x16x32_bf16 v[148:151], a[80:83], a[16:19], v[196:199]
  ds_read_b128 a[108:111], v227 offset:24576
  v_cvt_pk_bf16_f32 v178, v180, v181
  v_mfma_f32_16x16x32_bf16 v[148:151], a[84:87], a[20:23], v[148:151]
  v_exp_f32 v183, v183
  v_mfma_f32_16x16x32_bf16 v[148:151], a[88:91], a[24:27], v[148:151]
  v_exp_f32 v184, v184
  v_mfma_f32_16x16x32_bf16 v[148:151], a[92:95], a[28:31], v[148:151]
  ds_read_b128 a[112:115], v224 offset:28672
  v_cvt_pk_bf16_f32 v179, v182, v183
  v_mfma_f32_16x16x32_bf16 v[132:135], a[92:95], a[12:15], v[192:195]
  v_exp_f32 v185, v185
  v_mfma_f32_16x16x32_bf16 v[132:135], a[88:91], a[8:11], v[132:135]
  v_exp_f32 v186, v186
  v_mfma_f32_16x16x32_bf16 v[132:135], a[84:87], a[4:7], v[132:135]
  ds_read_b128 a[116:119], v225 offset:28672
  v_cvt_pk_bf16_f32 v184, v184, v185
  v_mfma_f32_16x16x32_bf16 v[132:135], a[80:83], a[0:3], v[132:135]
  v_exp_f32 v187, v187
  v_mfma_f32_16x16x32_bf16 v[220:223], a[192:195], v[176:179], 0
  s_waitcnt lgkmcnt(3)
  v_exp_f32 v188, v188
  v_mfma_f32_16x16x32_bf16 v[136:139], a[96:99], a[0:3], v[192:195]
  ds_read_b128 a[120:123], v226 offset:28672
  v_cvt_pk_bf16_f32 v185, v186, v187
  v_mfma_f32_16x16x32_bf16 v[136:139], a[100:103], a[4:7], v[136:139]
  v_exp_f32 v189, v189
  v_mfma_f32_16x16x32_bf16 v[136:139], a[104:107], a[8:11], v[136:139]
  s_waitcnt lgkmcnt(3)
  v_exp_f32 v190, v190
  v_mfma_f32_16x16x32_bf16 v[136:139], a[108:111], a[12:15], v[136:139]
  ds_read_b128 a[124:127], v227 offset:28672
  v_cvt_pk_bf16_f32 v186, v188, v189
  v_mfma_f32_16x16x32_bf16 v[152:155], a[108:111], a[28:31], v[196:199]
  v_exp_f32 v191, v191
  v_mfma_f32_16x16x32_bf16 v[152:155], a[104:107], a[24:27], v[152:155]
  v_cvt_pk_bf16_f32 v187, v190, v191
  v_xor_b32 v224, 0x8000, v224
  v_mfma_f32_16x16x32_bf16 v[152:155], a[100:103], a[20:23], v[152:155]
  v_xor_b32 v225, 0x8000, v225
  v_xor_b32 v226, 0x8000, v226
  v_mfma_f32_16x16x32_bf16 v[152:155], a[96:99], a[16:19], v[152:155]
  v_xor_b32 v227, 0x8000, v227
  v_mfma_f32_16x16x32_bf16 v[220:223], a[192:195], v[184:187], v[220:223]
  s_waitcnt lgkmcnt(2)
  v_mfma_f32_16x16x32_bf16 v[156:159], a[112:115], a[16:19], v[196:199]
  v_mfma_f32_16x16x32_bf16 v[156:159], a[116:119], a[20:23], v[156:159]
  s_waitcnt lgkmcnt(1)
  v_mfma_f32_16x16x32_bf16 v[156:159], a[120:123], a[24:27], v[156:159]
  s_waitcnt lgkmcnt(0)
  s_cmp_eq_u32 s35, 0
  v_mfma_f32_16x16x32_bf16 v[156:159], a[124:127], a[28:31], v[156:159]
  v_mfma_f32_16x16x32_bf16 v[140:143], a[124:127], a[12:15], v[192:195]
  v_mfma_f32_16x16x32_bf16 v[140:143], a[120:123], a[8:11], v[140:143]
  v_mfma_f32_16x16x32_bf16 v[140:143], a[116:119], a[4:7], v[140:143]
  v_max_f32 v246, v216, v220
  v_cmp_lt_f32 vcc, 0x49800000, v246
  v_mfma_f32_16x16x32_bf16 v[140:143], a[112:115], a[0:3], v[140:143]
  s_cbranch_vccnz L_slow_1
L_slow_1_ret:
  v_exp_f32 v128, v128
  s_cbranch_scc0 L_loop
L_tail:
  v_exp_f32 v129, v129
  v_exp_f32 v130, v130
  v_cvt_pk_bf16_f32 v128, v128, v129
  v_exp_f32 v131, v131
  v_exp_f32 v132, v132
  v_cvt_pk_bf16_f32 v129, v130, v131
  s_waitcnt vmcnt(0)
  s_barrier
  ds_read_b64_tr_b16 a[196:197], v228 offset:16384
  ds_read_b64_tr_b16 a[198:199], v228 offset:20480
  ds_read_b64_tr_b16 a[200:201], v228 offset:24576
  ds_read_b64_tr_b16 a[202:203], v228 offset:28672
  ds_read_b64_tr_b16 a[204:205], v229 offset:16384
  ds_read_b64_tr_b16 a[206:207], v229 offset:20480
  ds_read_b64_tr_b16 a[208:209], v229 offset:24576
  ds_read_b64_tr_b16 a[210:211], v229 offset:28672
  v_exp_f32 v133, v133
  v_exp_f32 v134, v134
  v_cvt_pk_bf16_f32 v130, v132, v133
  v_exp_f32 v135, v135
  v_exp_f32 v136, v136
  v_cvt_pk_bf16_f32 v131, v134, v135
  s_nop 1
  ds_read_b64_tr_b16 a[212:213], v230 offset:16384
  ds_read_b64_tr_b16 a[214:215], v230 offset:20480
  ds_read_b64_tr_b16 a[216:217], v230 offset:24576
  ds_read_b64_tr_b16 a[218:219], v230 offset:28672
  ds_read_b64_tr_b16 a[220:221], v231 offset:16384
  ds_read_b64_tr_b16 a[222:223], v231 offset:20480
  ds_read_b64_tr_b16 a[224:225], v231 offset:24576
  ds_read_b64_tr_b16 a[226:227], v231 offset:28672
  v_mfma_f32_16x16x32_bf16 v[208:211], a[192:195], v[128:131], 0
  s_waitcnt lgkmcnt(14)
  v_exp_f32 v137, v137
  v_exp_f32 v138, v138
  v_cvt_pk_bf16_f32 v136, v136, v137
  v_exp_f32 v139, v139
  v_exp_f32 v140, v140
  v_cvt_pk_bf16_f32 v137, v138, v139
  ds_read_b64_tr_b16 a[228:229], v232 offset:16384
  ds_read_b64_tr_b16 a[230:231], v232 offset:20480
  ds_read_b64_tr_b16 a[232:233], v232 offset:24576
  ds_read_b64_tr_b16 a[234:235], v232 offset:28672
  ds_read_b64_tr_b16 a[236:237], v233 offset:16384
  ds_read_b64_tr_b16 a[238:239], v233 offset:20480
  ds_read_b64_tr_b16 a[240:241], v233 offset:24576
  ds_read_b64_tr_b16 a[242:243], v233 offset:28672
  v_exp_f32 v141, v141
  v_exp_f32 v142, v142
  v_cvt_pk_bf16_f32 v138, v140, v141
  v_exp_f32 v143, v143
  s_nop 0
  v_cvt_pk_bf16_f32 v139, v142, v143
  s_nop 1
  v_mfma_f32_16x16x32_bf16 v[208:211], a[192:195], v[136:139], v[208:211]
  ds_read_b64_tr_b16 a[244:245], v234 offset:16384
  ds_read_b64_tr_b16 a[246:247], v234 offset:20480
  ds_read_b64_tr_b16 a[248:249], v234 offset:24576
  ds_read_b64_tr_b16 a[250:251], v234 offset:28672
  ds_read_b64_tr_b16 v[228:229], v235 offset:16384
  ds_read_b64_tr_b16 v[230:231], v235 offset:20480
  ds_read_b64_tr_b16 v[224:225], v235 offset:24576
  ds_read_b64_tr_b16 v[226:227], v235 offset:28672
  v_cmp_lt_f32 vcc, 0x49800000, v208
  v_add_f32 v244, v244, v216
  v_add_f32 v245, v245, v220
  v_xor_b32 v236, 64, v250
  s_nop 1
  s_cbranch_vccnz L_slow_z0
L_slow_z0_ret:
  v_mfma_f32_16x16x32_bf16 v[0:3], v[128:131], a[196:199], v[0:3]
  s_waitcnt lgkmcnt(15)
  v_exp_f32 v144, v144
  v_mfma_f32_16x16x32_bf16 v[0:3], v[136:139], a[200:203], v[0:3]
  s_waitcnt lgkmcnt(15)
  v_exp_f32 v145, v145
  v_mfma_f32_16x16x32_bf16 v[4:7], v[136:139], a[208:211], v[4:7]
  v_add_f32 v242, v242, v208
  v_mfma_f32_16x16x32_bf16 v[4:7], v[128:131], a[204:207], v[4:7]
  s_waitcnt lgkmcnt(15)
  v_rcp_f32 v242, v242
  v_mfma_f32_16x16x32_bf16 v[8:11], v[128:131], a[212:215], v[8:11]
  s_waitcnt lgkmcnt(15)
  v_exp_f32 v146, v146
  v_mfma_f32_16x16x32_bf16 v[8:11], v[136:139], a[216:219], v[8:11]
  s_waitcnt lgkmcnt(15)
  ds_bpermute_b32 v192, v240, v242 offset:0
  v_cvt_pk_bf16_f32 v144, v144, v145
  v_mfma_f32_16x16x32_bf16 v[12:15], v[136:139], a[224:227], v[12:15]
  v_exp_f32 v147, v147
  v_mfma_f32_16x16x32_bf16 v[12:15], v[128:131], a[220:223], v[12:15]
  s_waitcnt lgkmcnt(9)
  v_exp_f32 v148, v148
  v_mfma_f32_16x16x32_bf16 v[16:19], v[128:131], a[228:231], v[16:19]
  ds_bpermute_b32 v193, v240, v242 offset:4
  v_cvt_pk_bf16_f32 v145, v146, v147
  v_mfma_f32_16x16x32_bf16 v[16:19], v[136:139], a[232:235], v[16:19]
  v_exp_f32 v149, v149
  v_mfma_f32_16x16x32_bf16 v[20:23], v[136:139], a[240:243], v[20:23]
  v_exp_f32 v150, v150
  v_mfma_f32_16x16x32_bf16 v[20:23], v[128:131], a[236:239], v[20:23]
  s_waitcnt lgkmcnt(2)
  ds_bpermute_b32 v194, v240, v242 offset:8
  v_cvt_pk_bf16_f32 v146, v148, v149
  v_mfma_f32_16x16x32_bf16 v[24:27], v[128:131], a[244:247], v[24:27]
  v_exp_f32 v151, v151
  v_mfma_f32_16x16x32_bf16 v[24:27], v[136:139], a[248:251], v[24:27]
  v_exp_f32 v152, v152
  v_mfma_f32_16x16x32_bf16 v[28:31], v[136:139], v[224:227], v[28:31]
  ds_bpermute_b32 v195, v240, v242 offset:12
  v_cvt_pk_bf16_f32 v147, v150, v151
  v_mfma_f32_16x16x32_bf16 v[28:31], v[128:131], v[228:231], v[28:31]
  v_exp_f32 v153, v153
  v_mfma_f32_16x16x32_bf16 v[212:215], a[192:195], v[144:147], 0
  v_exp_f32 v154, v154
  v_cvt_pk_bf16_f32 v152, v152, v153
  v_exp_f32 v155, v155
  v_exp_f32 v156, v156
  v_cvt_pk_bf16_f32 v153, v154, v155
  v_exp_f32 v157, v157
  v_exp_f32 v158, v158
  v_cvt_pk_bf16_f32 v154, v156, v157
  v_exp_f32 v159, v159
  s_nop 0
  v_cvt_pk_bf16_f32 v155, v158, v159
  s_nop 1
  v_mfma_f32_16x16x32_bf16 v[212:215], a[192:195], v[152:155], v[212:215]
  s_waitcnt lgkmcnt(2)
  v_pk_mul_f32 v[0:1], v[0:1], v[192:193]
  s_waitcnt lgkmcnt(0)
  v_pk_mul_f32 v[2:3], v[2:3], v[194:195]
  v_pk_mul_f32 v[4:5], v[4:5], v[192:193]
  v_pk_mul_f32 v[6:7], v[6:7], v[194:195]
  v_pk_mul_f32 v[8:9], v[8:9], v[192:193]
  v_pk_mul_f32 v[10:11], v[10:11], v[194:195]
  v_pk_mul_f32 v[12:13], v[12:13], v[192:193]
  v_pk_mul_f32 v[14:15], v[14:15], v[194:195]
  v_cmp_lt_f32 vcc, 0x49800000, v212
  v_pk_mul_f32 v[16:17], v[16:17], v[192:193]
  v_pk_mul_f32 v[18:19], v[18:19], v[194:195]
  v_pk_mul_f32 v[20:21], v[20:21], v[192:193]
  v_pk_mul_f32 v[22:23], v[22:23], v[194:195]
  v_pk_mul_f32 v[24:25], v[24:25], v[192:193]
  v_pk_mul_f32 v[26:27], v[26:27], v[194:195]
  v_pk_mul_f32 v[28:29], v[28:29], v[192:193]
  v_pk_mul_f32 v[30:31], v[30:31], v[194:195]
  s_cbranch_vccnz L_slow_z1
L_slow_z1_ret:
  v_mfma_f32_16x16x32_bf16 v[32:35], v[144:147], a[196:199], v[32:35]
  v_add_f32 v243, v243, v212
  v_cvt_pk_bf16_f32 v128, v0, v4
  v_mfma_f32_16x16x32_bf16 v[32:35], v[152:155], a[200:203], v[32:35]
  v_cvt_pk_bf16_f32 v129, v8, v12
  v_cvt_pk_bf16_f32 v130, v16, v20
  v_mfma_f32_16x16x32_bf16 v[36:39], v[152:155], a[208:211], v[36:39]
  v_cvt_pk_bf16_f32 v131, v24, v28
  v_cvt_pk_bf16_f32 v132, v1, v5
  v_mfma_f32_16x16x32_bf16 v[36:39], v[144:147], a[204:207], v[36:39]
  ds_write_b128 v241, v[128:131] offset:0
  v_cvt_pk_bf16_f32 v133, v9, v13
  v_mfma_f32_16x16x32_bf16 v[40:43], v[144:147], a[212:215], v[40:43]
  v_cvt_pk_bf16_f32 v134, v17, v21
  v_cvt_pk_bf16_f32 v135, v25, v29
  v_mfma_f32_16x16x32_bf16 v[40:43], v[152:155], a[216:219], v[40:43]
  ds_write_b128 v249, v[132:135] offset:256
  v_cvt_pk_bf16_f32 v136, v2, v6
  v_mfma_f32_16x16x32_bf16 v[44:47], v[152:155], a[224:227], v[44:47]
  v_cvt_pk_bf16_f32 v137, v10, v14
  v_cvt_pk_bf16_f32 v138, v18, v22
  v_mfma_f32_16x16x32_bf16 v[44:47], v[144:147], a[220:223], v[44:47]
  v_cvt_pk_bf16_f32 v139, v26, v30
  v_cvt_pk_bf16_f32 v140, v3, v7
  v_mfma_f32_16x16x32_bf16 v[48:51], v[144:147], a[228:231], v[48:51]
  ds_write_b128 v241, v[136:139] offset:512
  v_cvt_pk_bf16_f32 v141, v11, v15
  v_mfma_f32_16x16x32_bf16 v[48:51], v[152:155], a[232:235], v[48:51]
  v_cvt_pk_bf16_f32 v142, v19, v23
  v_cvt_pk_bf16_f32 v143, v27, v31
  v_mfma_f32_16x16x32_bf16 v[52:55], v[152:155], a[240:243], v[52:55]
  ds_write_b128 v249, v[140:143] offset:768
  v_mfma_f32_16x16x32_bf16 v[52:55], v[144:147], a[236:239], v[52:55]
  ds_read_b64_tr_b16 v[0:1], v250 offset:0
  v_mfma_f32_16x16x32_bf16 v[56:59], v[144:147], a[244:247], v[56:59]
  ds_read_b64_tr_b16 v[2:3], v236 offset:0
  v_mfma_f32_16x16x32_bf16 v[56:59], v[152:155], a[248:251], v[56:59]
  ds_read_b64_tr_b16 v[4:5], v250 offset:1024
  v_mfma_f32_16x16x32_bf16 v[60:63], v[152:155], v[224:227], v[60:63]
  ds_read_b64_tr_b16 v[6:7], v236 offset:1024
  v_mfma_f32_16x16x32_bf16 v[60:63], v[144:147], v[228:231], v[60:63]
  ds_read_b64_tr_b16 v[8:9], v250 offset:2048
  v_rcp_f32 v243, v243
  ds_read_b64_tr_b16 v[10:11], v236 offset:2048
  ds_read_b64_tr_b16 v[12:13], v250 offset:3072
  ds_read_b64_tr_b16 v[14:15], v236 offset:3072
  ds_bpermute_b32 v196, v240, v243 offset:0
  ds_bpermute_b32 v197, v240, v243 offset:4
  ds_bpermute_b32 v198, v240, v243 offset:8
  ds_bpermute_b32 v199, v240, v243 offset:12
  v_mfma_f32_16x16x32_bf16 v[64:67], v[160:163], a[128:131], v[64:67]
  s_waitcnt lgkmcnt(3)
  v_mul_f32 v32, v32, v196
  v_mul_f32 v36, v36, v196
  v_mfma_f32_16x16x32_bf16 v[64:67], v[168:171], a[132:135], v[64:67]
  v_mul_f32 v40, v40, v196
  v_mul_f32 v44, v44, v196
  v_mfma_f32_16x16x32_bf16 v[96:99], v[184:187], a[132:135], v[96:99]
  buffer_store_dwordx4 v[0:3], v251, s[24:27], s31 offen offset:0 sc1
  v_mfma_f32_16x16x32_bf16 v[96:99], v[176:179], a[128:131], v[96:99]
  v_mul_f32 v48, v48, v196
  v_mul_f32 v52, v52, v196
  v_mfma_f32_16x16x32_bf16 v[100:103], v[176:179], a[136:139], v[100:103]
  v_mul_f32 v56, v56, v196
  v_mul_f32 v60, v60, v196
  v_mfma_f32_16x16x32_bf16 v[100:103], v[184:187], a[140:143], v[100:103]
  buffer_store_dwordx4 v[4:7], v251, s[24:27], s31 offen offset:1024 sc1
  v_mfma_f32_16x16x32_bf16 v[68:71], v[168:171], a[140:143], v[68:71]
  v_cvt_pk_bf16_f32 v144, v32, v36
  v_cvt_pk_bf16_f32 v145, v40, v44
  v_mfma_f32_16x16x32_bf16 v[68:71], v[160:163], a[136:139], v[68:71]
  v_cvt_pk_bf16_f32 v146, v48, v52
  v_cvt_pk_bf16_f32 v147, v56, v60
  v_mfma_f32_16x16x32_bf16 v[72:75], v[160:163], a[144:147], v[72:75]
  buffer_store_dwordx4 v[8:11], v251, s[24:27], s31 offen offset:2048 sc1
  v_mfma_f32_16x16x32_bf16 v[72:75], v[168:171], a[148:151], v[72:75]
  ds_write_b128 v241, v[144:147] offset:16384
  s_waitcnt lgkmcnt(3)
  v_mul_f32 v33, v33, v197
  v_mfma_f32_16x16x32_bf16 v[104:107], v[184:187], a[148:151], v[104:107]
  v_mul_f32 v37, v37, v197
  v_mul_f32 v41, v41, v197
  v_mfma_f32_16x16x32_bf16 v[104:107], v[176:179], a[144:147], v[104:107]
  v_mul_f32 v45, v45, v197
  v_mul_f32 v49, v49, v197
  v_mfma_f32_16x16x32_bf16 v[108:111], v[176:179], a[152:155], v[108:111]
  buffer_store_dwordx4 v[12:15], v251, s[24:27], s31 offen offset:3072 sc1
  v_mfma_f32_16x16x32_bf16 v[108:111], v[184:187], a[156:159], v[108:111]
  v_mul_f32 v53, v53, v197
  v_mul_f32 v57, v57, v197
  v_mfma_f32_16x16x32_bf16 v[76:79], v[168:171], a[156:159], v[76:79]
  v_mul_f32 v61, v61, v197
  v_cvt_pk_bf16_f32 v148, v33, v37
  v_mfma_f32_16x16x32_bf16 v[76:79], v[160:163], a[152:155], v[76:79]
  v_cvt_pk_bf16_f32 v149, v41, v45
  v_cvt_pk_bf16_f32 v150, v49, v53
  v_mfma_f32_16x16x32_bf16 v[80:83], v[160:163], a[160:163], v[80:83]
  v_cvt_pk_bf16_f32 v151, v57, v61
  s_waitcnt lgkmcnt(2)
  v_mul_f32 v34, v34, v198
  v_mfma_f32_16x16x32_bf16 v[80:83], v[168:171], a[164:167], v[80:83]
  ds_write_b128 v249, v[148:151] offset:16640
  v_mul_f32 v38, v38, v198
  v_mfma_f32_16x16x32_bf16 v[112:115], v[184:187], a[164:167], v[112:115]
  v_mul_f32 v42, v42, v198
  v_mul_f32 v46, v46, v198
  v_mfma_f32_16x16x32_bf16 v[112:115], v[176:179], a[160:163], v[112:115]
  v_mul_f32 v50, v50, v198
  v_mul_f32 v54, v54, v198
  v_mfma_f32_16x16x32_bf16 v[116:119], v[176:179], a[168:171], v[116:119]
  v_mul_f32 v58, v58, v198
  v_mul_f32 v62, v62, v198
  v_mfma_f32_16x16x32_bf16 v[116:119], v[184:187], a[172:175], v[116:119]
  v_cvt_pk_bf16_f32 v152, v34, v38
  v_cvt_pk_bf16_f32 v153, v42, v46
  v_mfma_f32_16x16x32_bf16 v[84:87], v[168:171], a[172:175], v[84:87]
  v_cvt_pk_bf16_f32 v154, v50, v54
  v_cvt_pk_bf16_f32 v155, v58, v62
  v_mfma_f32_16x16x32_bf16 v[84:87], v[160:163], a[168:171], v[84:87]
  ds_write_b128 v241, v[152:155] offset:16896
  s_waitcnt lgkmcnt(3)
  v_mul_f32 v35, v35, v199
  v_mfma_f32_16x16x32_bf16 v[88:91], v[160:163], a[176:179], v[88:91]
  v_mul_f32 v39, v39, v199
  v_mul_f32 v43, v43, v199
  v_mfma_f32_16x16x32_bf16 v[88:91], v[168:171], a[180:183], v[88:91]
  v_mul_f32 v47, v47, v199
  v_mul_f32 v51, v51, v199
  v_mfma_f32_16x16x32_bf16 v[120:123], v[184:187], a[180:183], v[120:123]
  v_mul_f32 v55, v55, v199
  v_mul_f32 v59, v59, v199
  v_mfma_f32_16x16x32_bf16 v[120:123], v[176:179], a[176:179], v[120:123]
  v_mul_f32 v63, v63, v199
  v_cvt_pk_bf16_f32 v156, v35, v39
  v_mfma_f32_16x16x32_bf16 v[124:127], v[176:179], a[184:187], v[124:127]
  v_cvt_pk_bf16_f32 v157, v43, v47
  v_cvt_pk_bf16_f32 v158, v51, v55
  v_mfma_f32_16x16x32_bf16 v[124:127], v[184:187], a[188:191], v[124:127]
  v_cvt_pk_bf16_f32 v159, v59, v63
  v_mfma_f32_16x16x32_bf16 v[92:95], v[168:171], a[188:191], v[92:95]
  ds_write_b128 v249, v[156:159] offset:17152
  v_mfma_f32_16x16x32_bf16 v[92:95], v[160:163], a[184:187], v[92:95]
  ds_read_b64_tr_b16 v[32:33], v250 offset:16384
  v_mfma_f32_16x16x32_bf16 v[160:163], a[64:67], a[32:35], v[200:203]
  ds_read_b64_tr_b16 v[34:35], v236 offset:16384
  v_mfma_f32_16x16x32_bf16 v[160:163], a[68:71], a[36:39], v[160:163]
  ds_read_b64_tr_b16 v[36:37], v250 offset:17408
  v_mfma_f32_16x16x32_bf16 v[160:163], a[72:75], a[40:43], v[160:163]
  ds_read_b64_tr_b16 v[38:39], v236 offset:17408
  v_mfma_f32_16x16x32_bf16 v[160:163], a[76:79], a[44:47], v[160:163]
  ds_read_b64_tr_b16 v[40:41], v250 offset:18432
  v_mfma_f32_16x16x32_bf16 v[164:167], a[80:83], a[32:35], v[200:203]
  ds_read_b64_tr_b16 v[42:43], v236 offset:18432
  v_mfma_f32_16x16x32_bf16 v[164:167], a[84:87], a[36:39], v[164:167]
  ds_read_b64_tr_b16 v[44:45], v250 offset:19456
  v_mfma_f32_16x16x32_bf16 v[164:167], a[88:91], a[40:43], v[164:167]
  ds_read_b64_tr_b16 v[46:47], v236 offset:19456
  v_mfma_f32_16x16x32_bf16 v[164:167], a[92:95], a[44:47], v[164:167]
  v_mfma_f32_16x16x32_bf16 v[168:171], a[96:99], a[32:35], v[200:203]
  v_mfma_f32_16x16x32_bf16 v[168:171], a[100:103], a[36:39], v[168:171]
  s_waitcnt lgkmcnt(6)
  buffer_store_dwordx4 v[32:35], v251, s[24:27], s32 offen offset:0 sc1
  v_mfma_f32_16x16x32_bf16 v[168:171], a[104:107], a[40:43], v[168:171]
  v_exp_f32 v160, v160
  v_mfma_f32_16x16x32_bf16 v[168:171], a[108:111], a[44:47], v[168:171]
  s_waitcnt lgkmcnt(4)
  buffer_store_dwordx4 v[36:39], v251, s[24:27], s32 offen offset:1024 sc1
  v_mfma_f32_16x16x32_bf16 v[172:175], a[112:115], a[32:35], v[200:203]
  v_exp_f32 v161, v161
  v_mfma_f32_16x16x32_bf16 v[172:175], a[116:119], a[36:39], v[172:175]
  v_exp_f32 v162, v162
  v_mfma_f32_16x16x32_bf16 v[172:175], a[120:123], a[40:43], v[172:175]
  v_cvt_pk_bf16_f32 v160, v160, v161
  v_mfma_f32_16x16x32_bf16 v[172:175], a[124:127], a[44:47], v[172:175]
  s_waitcnt lgkmcnt(2)
  buffer_store_dwordx4 v[40:43], v251, s[24:27], s32 offen offset:2048 sc1
  v_mfma_f32_16x16x32_bf16 v[176:179], a[64:67], a[48:51], v[204:207]
  v_exp_f32 v163, v163
  v_mfma_f32_16x16x32_bf16 v[176:179], a[68:71], a[52:55], v[176:179]
  v_exp_f32 v164, v164
  v_mfma_f32_16x16x32_bf16 v[176:179], a[72:75], a[56:59], v[176:179]
  v_cvt_pk_bf16_f32 v161, v162, v163
  v_mfma_f32_16x16x32_bf16 v[176:179], a[76:79], a[60:63], v[176:179]
  s_waitcnt lgkmcnt(0)
  buffer_store_dwordx4 v[44:47], v251, s[24:27], s32 offen offset:3072 sc1
  v_mfma_f32_16x16x32_bf16 v[180:183], a[80:83], a[48:51], v[204:207]
  v_exp_f32 v165, v165
  v_mfma_f32_16x16x32_bf16 v[180:183], a[84:87], a[52:55], v[180:183]
  v_exp_f32 v166, v166
  v_mfma_f32_16x16x32_bf16 v[180:183], a[88:91], a[56:59], v[180:183]
  v_cvt_pk_bf16_f32 v162, v164, v165
  v_mfma_f32_16x16x32_bf16 v[180:183], a[92:95], a[60:63], v[180:183]
  v_exp_f32 v167, v167
  v_mfma_f32_16x16x32_bf16 v[184:187], a[96:99], a[48:51], v[204:207]
  v_exp_f32 v168, v168
  v_mfma_f32_16x16x32_bf16 v[184:187], a[100:103], a[52:55], v[184:187]
  v_cvt_pk_bf16_f32 v163, v166, v167
  v_mfma_f32_16x16x32_bf16 v[184:187], a[104:107], a[56:59], v[184:187]
  v_exp_f32 v169, v169
  v_mfma_f32_16x16x32_bf16 v[184:187], a[108:111], a[60:63], v[184:187]
  v_exp_f32 v170, v170
  v_mfma_f32_16x16x32_bf16 v[216:219], a[192:195], v[160:163], 0
  v_cvt_pk_bf16_f32 v168, v168, v169
  v_mfma_f32_16x16x32_bf16 v[188:191], a[112:115], a[48:51], v[204:207]
  v_exp_f32 v171, v171
  v_mfma_f32_16x16x32_bf16 v[188:191], a[116:119], a[52:55], v[188:191]
  v_exp_f32 v172, v172
  v_mfma_f32_16x16x32_bf16 v[188:191], a[120:123], a[56:59], v[188:191]
  v_cvt_pk_bf16_f32 v169, v170, v171
  v_mfma_f32_16x16x32_bf16 v[188:191], a[124:127], a[60:63], v[188:191]
  v_exp_f32 v173, v173
  v_exp_f32 v174, v174
  v_cvt_pk_bf16_f32 v170, v172, v173
  v_exp_f32 v175, v175
  s_nop 0
  v_cvt_pk_bf16_f32 v171, v174, v175
  s_nop 1
  v_mfma_f32_16x16x32_bf16 v[216:219], a[192:195], v[168:171], v[216:219]
  v_exp_f32 v176, v176
  v_exp_f32 v177, v177
  v_exp_f32 v178, v178
  v_cvt_pk_bf16_f32 v176, v176, v177
  v_exp_f32 v179, v179
  v_exp_f32 v180, v180
  v_cvt_pk_bf16_f32 v177, v178, v179
  v_exp_f32 v181, v181
  v_cmp_lt_f32 vcc, 0x49800000, v216
  v_exp_f32 v182, v182
  v_cvt_pk_bf16_f32 v178, v180, v181
  v_exp_f32 v183, v183
  s_cbranch_vccnz L_slow_z4
L_slow_z4_ret:
  v_mfma_f32_16x16x32_bf16 v[64:67], v[160:163], a[196:199], v[64:67]
  v_exp_f32 v184, v184
  v_mfma_f32_16x16x32_bf16 v[64:67], v[168:171], a[200:203], v[64:67]
  v_add_f32 v244, v244, v216
  v_cvt_pk_bf16_f32 v179, v182, v183
  v_mfma_f32_16x16x32_bf16 v[68:71], v[168:171], a[208:211], v[68:71]
  s_add_u32 s31, s31, 8192
  v_exp_f32 v185, v185
  v_mfma_f32_16x16x32_bf16 v[68:71], v[160:163], a[204:207], v[68:71]
  v_rcp_f32 v244, v244
  v_mfma_f32_16x16x32_bf16 v[220:223], a[192:195], v[176:179], 0
  s_add_u32 s32, s32, 8192
  v_exp_f32 v186, v186
  v_mfma_f32_16x16x32_bf16 v[72:75], v[160:163], a[212:215], v[72:75]
  ds_bpermute_b32 v200, v240, v244 offset:0
  v_cvt_pk_bf16_f32 v184, v184, v185
  v_mfma_f32_16x16x32_bf16 v[72:75], v[168:171], a[216:219], v[72:75]
  v_exp_f32 v187, v187
  v_mfma_f32_16x16x32_bf16 v[76:79], v[168:171], a[224:227], v[76:79]
  v_exp_f32 v188, v188
  v_mfma_f32_16x16x32_bf16 v[76:79], v[160:163], a[220:223], v[76:79]
  ds_bpermute_b32 v201, v240, v244 offset:4
  v_cvt_pk_bf16_f32 v185, v186, v187
  v_mfma_f32_16x16x32_bf16 v[80:83], v[160:163], a[228:231], v[80:83]
  v_exp_f32 v189, v189
  v_mfma_f32_16x16x32_bf16 v[80:83], v[168:171], a[232:235], v[80:83]
  ds_bpermute_b32 v202, v240, v244 offset:8
  v_mfma_f32_16x16x32_bf16 v[84:87], v[168:171], a[240:243], v[84:87]
  v_exp_f32 v190, v190
  v_mfma_f32_16x16x32_bf16 v[84:87], v[160:163], a[236:239], v[84:87]
  ds_bpermute_b32 v203, v240, v244 offset:12
  v_cvt_pk_bf16_f32 v186, v188, v189
  v_mfma_f32_16x16x32_bf16 v[88:91], v[160:163], a[244:247], v[88:91]
  v_exp_f32 v191, v191
  v_mfma_f32_16x16x32_bf16 v[88:91], v[168:171], a[248:251], v[88:91]
  v_cvt_pk_bf16_f32 v187, v190, v191
  v_mfma_f32_16x16x32_bf16 v[92:95], v[168:171], v[224:227], v[92:95]
  v_mfma_f32_16x16x32_bf16 v[92:95], v[160:163], v[228:231], v[92:95]
  v_mfma_f32_16x16x32_bf16 v[220:223], a[192:195], v[184:187], v[220:223]
  v_add_u32 v241, 0x10000, v241
  v_add_u32 v249, 0x10000, v249
  v_add_u32 v250, 0x10000, v250
  v_add_u32 v236, 0x10000, v236
  s_waitcnt lgkmcnt(2)
  v_pk_mul_f32 v[64:65], v[64:65], v[200:201]
  s_waitcnt lgkmcnt(0)
  v_pk_mul_f32 v[66:67], v[66:67], v[202:203]
  v_pk_mul_f32 v[68:69], v[68:69], v[200:201]
  v_pk_mul_f32 v[70:71], v[70:71], v[202:203]
  v_cmp_lt_f32 vcc, 0x49800000, v220
  v_pk_mul_f32 v[72:73], v[72:73], v[200:201]
  v_pk_mul_f32 v[74:75], v[74:75], v[202:203]
  v_pk_mul_f32 v[76:77], v[76:77], v[200:201]
  v_pk_mul_f32 v[78:79], v[78:79], v[202:203]
  v_pk_mul_f32 v[80:81], v[80:81], v[200:201]
  v_pk_mul_f32 v[82:83], v[82:83], v[202:203]
  v_pk_mul_f32 v[84:85], v[84:85], v[200:201]
  v_pk_mul_f32 v[86:87], v[86:87], v[202:203]
  v_pk_mul_f32 v[88:89], v[88:89], v[200:201]
  v_pk_mul_f32 v[90:91], v[90:91], v[202:203]
  v_pk_mul_f32 v[92:93], v[92:93], v[200:201]
  v_pk_mul_f32 v[94:95], v[94:95], v[202:203]
  s_cbranch_vccnz L_slow_z5
L_slow_z5_ret:
  v_mfma_f32_16x16x32_bf16 v[96:99], v[176:179], a[196:199], v[96:99]
  v_add_f32 v245, v245, v220
  v_rcp_f32 v245, v245
  v_mfma_f32_16x16x32_bf16 v[96:99], v[184:187], a[200:203], v[96:99]
  v_cvt_pk_bf16_f32 v128, v64, v68
  v_cvt_pk_bf16_f32 v129, v72, v76
  v_mfma_f32_16x16x32_bf16 v[100:103], v[184:187], a[208:211], v[100:103]
  ds_bpermute_b32 v204, v240, v245 offset:0
  v_cvt_pk_bf16_f32 v130, v80, v84
  v_mfma_f32_16x16x32_bf16 v[100:103], v[176:179], a[204:207], v[100:103]
  ds_bpermute_b32 v205, v240, v245 offset:4
  v_cvt_pk_bf16_f32 v131, v88, v92
  v_mfma_f32_16x16x32_bf16 v[104:107], v[176:179], a[212:215], v[104:107]
  ds_bpermute_b32 v206, v240, v245 offset:8
  v_cvt_pk_bf16_f32 v132, v65, v69
  v_mfma_f32_16x16x32_bf16 v[104:107], v[184:187], a[216:219], v[104:107]
  ds_bpermute_b32 v207, v240, v245 offset:12
  v_cvt_pk_bf16_f32 v133, v73, v77
  v_mfma_f32_16x16x32_bf16 v[108:111], v[184:187], a[224:227], v[108:111]
  ds_write_b128 v241, v[128:131] offset:0
  v_cvt_pk_bf16_f32 v134, v81, v85
  v_mfma_f32_16x16x32_bf16 v[108:111], v[176:179], a[220:223], v[108:111]
  v_cvt_pk_bf16_f32 v135, v89, v93
  v_cvt_pk_bf16_f32 v136, v66, v70
  v_mfma_f32_16x16x32_bf16 v[112:115], v[176:179], a[228:231], v[112:115]
  ds_write_b128 v249, v[132:135] offset:256
  v_cvt_pk_bf16_f32 v137, v74, v78
  v_mfma_f32_16x16x32_bf16 v[112:115], v[184:187], a[232:235], v[112:115]
  v_cvt_pk_bf16_f32 v138, v82, v86
  v_cvt_pk_bf16_f32 v139, v90, v94
  v_mfma_f32_16x16x32_bf16 v[116:119], v[184:187], a[240:243], v[116:119]
  ds_write_b128 v241, v[136:139] offset:512
  v_cvt_pk_bf16_f32 v140, v67, v71
  v_mfma_f32_16x16x32_bf16 v[116:119], v[176:179], a[236:239], v[116:119]
  v_cvt_pk_bf16_f32 v141, v75, v79
  v_cvt_pk_bf16_f32 v142, v83, v87
  v_mfma_f32_16x16x32_bf16 v[120:123], v[176:179], a[244:247], v[120:123]
  v_cvt_pk_bf16_f32 v143, v91, v95
  v_mfma_f32_16x16x32_bf16 v[120:123], v[184:187], a[248:251], v[120:123]
  ds_write_b128 v249, v[140:143] offset:768
  v_mfma_f32_16x16x32_bf16 v[124:127], v[184:187], v[224:227], v[124:127]
  ds_read_b64_tr_b16 v[64:65], v250 offset:0
  v_mfma_f32_16x16x32_bf16 v[124:127], v[176:179], v[228:231], v[124:127]
  ds_read_b64_tr_b16 v[66:67], v236 offset:0
  ds_read_b64_tr_b16 v[68:69], v250 offset:1024
  ds_read_b64_tr_b16 v[70:71], v236 offset:1024
  ds_read_b64_tr_b16 v[72:73], v250 offset:2048
  ds_read_b64_tr_b16 v[74:75], v236 offset:2048
  ds_read_b64_tr_b16 v[76:77], v250 offset:3072
  ds_read_b64_tr_b16 v[78:79], v236 offset:3072
  s_waitcnt lgkmcnt(14)
  v_pk_mul_f32 v[96:97], v[96:97], v[204:205]
  s_waitcnt lgkmcnt(12)
  v_pk_mul_f32 v[98:99], v[98:99], v[206:207]
  v_pk_mul_f32 v[100:101], v[100:101], v[204:205]
  v_pk_mul_f32 v[102:103], v[102:103], v[206:207]
  v_pk_mul_f32 v[104:105], v[104:105], v[204:205]
  v_pk_mul_f32 v[106:107], v[106:107], v[206:207]
  v_pk_mul_f32 v[108:109], v[108:109], v[204:205]
  v_pk_mul_f32 v[110:111], v[110:111], v[206:207]
  s_waitcnt lgkmcnt(6)
  buffer_store_dwordx4 v[64:67], v251, s[24:27], s31 offen offset:0 sc1
  v_pk_mul_f32 v[112:113], v[112:113], v[204:205]
  v_pk_mul_f32 v[114:115], v[114:115], v[206:207]
  v_pk_mul_f32 v[116:117], v[116:117], v[204:205]
  v_pk_mul_f32 v[118:119], v[118:119], v[206:207]
  v_pk_mul_f32 v[120:121], v[120:121], v[204:205]
  v_pk_mul_f32 v[122:123], v[122:123], v[206:207]
  v_pk_mul_f32 v[124:125], v[124:125], v[204:205]
  v_pk_mul_f32 v[126:127], v[126:127], v[206:207]
  v_cvt_pk_bf16_f32 v144, v96, v100
  v_cvt_pk_bf16_f32 v145, v104, v108
  s_waitcnt lgkmcnt(4)
  buffer_store_dwordx4 v[68:71], v251, s[24:27], s31 offen offset:1024 sc1
  v_cvt_pk_bf16_f32 v146, v112, v116
  v_cvt_pk_bf16_f32 v147, v120, v124
  ds_write_b128 v241, v[144:147] offset:16384
  v_cvt_pk_bf16_f32 v148, v97, v101
  v_cvt_pk_bf16_f32 v149, v105, v109
  v_cvt_pk_bf16_f32 v150, v113, v117
  v_cvt_pk_bf16_f32 v151, v121, v125
  ds_write_b128 v249, v[148:151] offset:16640
  v_cvt_pk_bf16_f32 v152, v98, v102
  s_waitcnt lgkmcnt(4)
  buffer_store_dwordx4 v[72:75], v251, s[24:27], s31 offen offset:2048 sc1
  v_cvt_pk_bf16_f32 v153, v106, v110
  v_cvt_pk_bf16_f32 v154, v114, v118
  v_cvt_pk_bf16_f32 v155, v122, v126
  ds_write_b128 v241, v[152:155] offset:16896
  v_cvt_pk_bf16_f32 v156, v99, v103
  v_cvt_pk_bf16_f32 v157, v107, v111
  v_cvt_pk_bf16_f32 v158, v115, v119
  v_cvt_pk_bf16_f32 v159, v123, v127
  ds_write_b128 v249, v[156:159] offset:17152
  s_waitcnt lgkmcnt(4)
  buffer_store_dwordx4 v[76:79], v251, s[24:27], s31 offen offset:3072 sc1
  ds_read_b64_tr_b16 v[96:97], v250 offset:16384
  ds_read_b64_tr_b16 v[98:99], v236 offset:16384
  ds_read_b64_tr_b16 v[100:101], v250 offset:17408
  ds_read_b64_tr_b16 v[102:103], v236 offset:17408
  ds_read_b64_tr_b16 v[104:105], v250 offset:18432
  ds_read_b64_tr_b16 v[106:107], v236 offset:18432
  ds_read_b64_tr_b16 v[108:109], v250 offset:19456
  ds_read_b64_tr_b16 v[110:111], v236 offset:19456
  s_waitcnt lgkmcnt(6)
  buffer_store_dwordx4 v[96:99], v251, s[24:27], s32 offen offset:0 sc1
  s_waitcnt lgkmcnt(4)
  buffer_store_dwordx4 v[100:103], v251, s[24:27], s32 offen offset:1024 sc1
  s_waitcnt lgkmcnt(2)
  buffer_store_dwordx4 v[104:107], v251, s[24:27], s32 offen offset:2048 sc1
  s_waitcnt lgkmcnt(0)
  buffer_store_dwordx4 v[108:111], v251, s[24:27], s32 offen offset:3072 sc1
L_end:
  s_endpgm
L_slow_2:
  s_nop 3
  s_waitcnt lgkmcnt(0)
  v_mfma_f32_16x16x32_bf16 v[128:131], a[64:67], a[0:3], v[192:195]
  v_mfma_f32_16x16x32_bf16 v[128:131], a[68:71], a[4:7], v[128:131]
  v_mfma_f32_16x16x32_bf16 v[128:131], a[72:75], a[8:11], v[128:131]
  v_mfma_f32_16x16x32_bf16 v[128:131], a[76:79], a[12:15], v[128:131]
  v_mfma_f32_16x16x32_bf16 v[144:147], a[76:79], a[28:31], v[196:199]
  v_mfma_f32_16x16x32_bf16 v[144:147], a[72:75], a[24:27], v[144:147]
  v_mfma_f32_16x16x32_bf16 v[144:147], a[68:71], a[20:23], v[144:147]
  v_mfma_f32_16x16x32_bf16 v[144:147], a[64:67], a[16:19], v[144:147]
  v_mfma_f32_16x16x32_bf16 v[148:151], a[80:83], a[16:19], v[196:199]
  v_mfma_f32_16x16x32_bf16 v[148:151], a[84:87], a[20:23], v[148:151]
  v_mfma_f32_16x16x32_bf16 v[148:151], a[88:91], a[24:27], v[148:151]
  v_mfma_f32_16x16x32_bf16 v[148:151], a[92:95], a[28:31], v[148:151]
  v_mfma_f32_16x16x32_bf16 v[132:135], a[92:95], a[12:15], v[192:195]
  v_mfma_f32_16x16x32_bf16 v[132:135], a[88:91], a[8:11], v[132:135]
  v_mfma_f32_16x16x32_bf16 v[132:135], a[84:87], a[4:7], v[132:135]
  v_mfma_f32_16x16x32_bf16 v[132:135], a[80:83], a[0:3], v[132:135]
  v_mfma_f32_16x16x32_bf16 v[136:139], a[96:99], a[0:3], v[192:195]
  v_mfma_f32_16x16x32_bf16 v[136:139], a[100:103], a[4:7], v[136:139]
  v_mfma_f32_16x16x32_bf16 v[136:139], a[104:107], a[8:11], v[136:139]
  v_mfma_f32_16x16x32_bf16 v[136:139], a[108:111], a[12:15], v[136:139]
  v_mfma_f32_16x16x32_bf16 v[152:155], a[108:111], a[28:31], v[196:199]
  v_mfma_f32_16x16x32_bf16 v[152:155], a[104:107], a[24:27], v[152:155]
  v_mfma_f32_16x16x32_bf16 v[152:155], a[100:103], a[20:23], v[152:155]
  v_mfma_f32_16x16x32_bf16 v[152:155], a[96:99], a[16:19], v[152:155]
  v_mfma_f32_16x16x32_bf16 v[156:159], a[112:115], a[16:19], v[196:199]
  v_mfma_f32_16x16x32_bf16 v[156:159], a[116:119], a[20:23], v[156:159]
  v_mfma_f32_16x16x32_bf16 v[156:159], a[120:123], a[24:27], v[156:159]
  v_mfma_f32_16x16x32_bf16 v[156:159], a[124:127], a[28:31], v[156:159]
  v_mfma_f32_16x16x32_bf16 v[140:143], a[124:127], a[12:15], v[192:195]
  v_mfma_f32_16x16x32_bf16 v[140:143], a[120:123], a[8:11], v[140:143]
  v_mfma_f32_16x16x32_bf16 v[140:143], a[116:119], a[4:7], v[140:143]
  v_mfma_f32_16x16x32_bf16 v[140:143], a[112:115], a[0:3], v[140:143]
  s_nop 7
  v_max3_f32 v246, v128, v129, v130
  v_max3_f32 v247, v131, v132, v133
  v_max3_f32 v246, v246, v134, v135
  v_max3_f32 v247, v247, v136, v137
  v_max3_f32 v246, v246, v138, v139
  v_max3_f32 v247, v247, v140, v141
  v_max3_f32 v246, v246, v142, v143
  v_max_f32 v246, v246, v247
  v_mov_b32 v247, v246
  s_nop 1
  v_permlane16_swap_b32 v246, v247
  s_nop 1
  v_max_f32 v246, v246, v247
  v_mov_b32 v247, v246
  s_nop 1
  v_permlane32_swap_b32 v246, v247
  s_nop 1
  v_max_f32 v246, v246, v247
  v_max_f32 v246, 0, v246
  v_exp_f32 v248, -v246
  v_sub_f32 v192, v192, v246
  v_sub_f32 v193, v193, v246
  v_sub_f32 v194, v194, v246
  v_sub_f32 v195, v195, v246
  v_mul_f32 v242, v242, v248
  ds_bpermute_b32 v252, v240, v248 offset:0
  ds_bpermute_b32 v253, v240, v248 offset:4
  ds_bpermute_b32 v254, v240, v248 offset:8
  ds_bpermute_b32 v255, v240, v248 offset:12
  v_sub_f32 v128, v128, v246
  v_sub_f32 v129, v129, v246
  v_sub_f32 v130, v130, v246
  v_sub_f32 v131, v131, v246
  v_sub_f32 v132, v132, v246
  v_sub_f32 v133, v133, v246
  v_sub_f32 v134, v134, v246
  v_sub_f32 v135, v135, v246
  v_sub_f32 v136, v136, v246
  v_sub_f32 v137, v137, v246
  v_sub_f32 v138, v138, v246
  v_sub_f32 v139, v139, v246
  v_sub_f32 v140, v140, v246
  v_sub_f32 v141, v141, v246
  v_sub_f32 v142, v142, v246
  v_sub_f32 v143, v143, v246
  s_waitcnt lgkmcnt(0)
  v_mul_f32 v0, v0, v252
  v_mul_f32 v1, v1, v253
  v_mul_f32 v2, v2, v254
  v_mul_f32 v3, v3, v255
  v_mul_f32 v4, v4, v252
  v_mul_f32 v5, v5, v253
  v_mul_f32 v6, v6, v254
  v_mul_f32 v7, v7, v255
  v_mul_f32 v8, v8, v252
  v_mul_f32 v9, v9, v253
  v_mul_f32 v10, v10, v254
  v_mul_f32 v11, v11, v255
  v_mul_f32 v12, v12, v252
  v_mul_f32 v13, v13, v253
  v_mul_f32 v14, v14, v254
  v_mul_f32 v15, v15, v255
  v_mul_f32 v16, v16, v252
  v_mul_f32 v17, v17, v253
  v_mul_f32 v18, v18, v254
  v_mul_f32 v19, v19, v255
  v_mul_f32 v20, v20, v252
  v_mul_f32 v21, v21, v253
  v_mul_f32 v22, v22, v254
  v_mul_f32 v23, v23, v255
  v_mul_f32 v24, v24, v252
  v_mul_f32 v25, v25, v253
  v_mul_f32 v26, v26, v254
  v_mul_f32 v27, v27, v255
  v_mul_f32 v28, v28, v252
  v_mul_f32 v29, v29, v253
  v_mul_f32 v30, v30, v254
  v_mul_f32 v31, v31, v255
  v_max3_f32 v246, v144, v145, v146
  v_max3_f32 v247, v147, v148, v149
  v_max3_f32 v246, v246, v150, v151
  v_max3_f32 v247, v247, v152, v153
  v_max3_f32 v246, v246, v154, v155
  v_max3_f32 v247, v247, v156, v157
  v_max3_f32 v246, v246, v158, v159
  v_max_f32 v246, v246, v247
  v_mov_b32 v247, v246
  s_nop 1
  v_permlane16_swap_b32 v246, v247
  s_nop 1
  v_max_f32 v246, v246, v247
  v_mov_b32 v247, v246
  s_nop 1
  v_permlane32_swap_b32 v246, v247
  s_nop 1
  v_max_f32 v246, v246, v247
  v_max_f32 v246, 0, v246
  v_exp_f32 v248, -v246
  v_sub_f32 v196, v196, v246
  v_sub_f32 v197, v197, v246
  v_sub_f32 v198, v198, v246
  v_sub_f32 v199, v199, v246
  v_mul_f32 v243, v243, v248
  ds_bpermute_b32 v252, v240, v248 offset:0
  ds_bpermute_b32 v253, v240, v248 offset:4
  ds_bpermute_b32 v254, v240, v248 offset:8
  ds_bpermute_b32 v255, v240, v248 offset:12
  v_sub_f32 v144, v144, v246
  v_sub_f32 v145, v145, v246
  v_sub_f32 v146, v146, v246
  v_sub_f32 v147, v147, v246
  v_sub_f32 v148, v148, v246
  v_sub_f32 v149, v149, v246
  v_sub_f32 v150, v150, v246
  v_sub_f32 v151, v151, v246
  v_sub_f32 v152, v152, v246
  v_sub_f32 v153, v153, v246
  v_sub_f32 v154, v154, v246
  v_sub_f32 v155, v155, v246
  v_sub_f32 v156, v156, v246
  v_sub_f32 v157, v157, v246
  v_sub_f32 v158, v158, v246
  v_sub_f32 v159, v159, v246
  s_waitcnt lgkmcnt(0)
  v_mul_f32 v32, v32, v252
  v_mul_f32 v33, v33, v253
  v_mul_f32 v34, v34, v254
  v_mul_f32 v35, v35, v255
  v_mul_f32 v36, v36, v252
  v_mul_f32 v37, v37, v253
  v_mul_f32 v38, v38, v254
  v_mul_f32 v39, v39, v255
  v_mul_f32 v40, v40, v252
  v_mul_f32 v41, v41, v253
  v_mul_f32 v42, v42, v254
  v_mul_f32 v43, v43, v255
  v_mul_f32 v44, v44, v252
  v_mul_f32 v45, v45, v253
  v_mul_f32 v46, v46, v254
  v_mul_f32 v47, v47, v255
  v_mul_f32 v48, v48, v252
  v_mul_f32 v49, v49, v253
  v_mul_f32 v50, v50, v254
  v_mul_f32 v51, v51, v255
  v_mul_f32 v52, v52, v252
  v_mul_f32 v53, v53, v253
  v_mul_f32 v54, v54, v254
  v_mul_f32 v55, v55, v255
  v_mul_f32 v56, v56, v252
  v_mul_f32 v57, v57, v253
  v_mul_f32 v58, v58, v254
  v_mul_f32 v59, v59, v255
  v_mul_f32 v60, v60, v252
  v_mul_f32 v61, v61, v253
  v_mul_f32 v62, v62, v254
  v_mul_f32 v63, v63, v255
  v_exp_f32 v128, v128
  v_exp_f32 v129, v129
  v_exp_f32 v130, v130
  v_cvt_pk_bf16_f32 v128, v128, v129
  v_exp_f32 v131, v131
  v_exp_f32 v132, v132
  v_cvt_pk_bf16_f32 v129, v130, v131
  v_exp_f32 v133, v133
  v_exp_f32 v134, v134
  v_cvt_pk_bf16_f32 v130, v132, v133
  v_exp_f32 v135, v135
  v_exp_f32 v136, v136
  v_cvt_pk_bf16_f32 v131, v134, v135
  s_nop 1
  v_mfma_f32_16x16x32_bf16 v[208:211], a[192:195], v[128:131], 0
  v_exp_f32 v137, v137
  v_exp_f32 v138, v138
  v_cvt_pk_bf16_f32 v136, v136, v137
  v_exp_f32 v139, v139
  v_exp_f32 v140, v140
  v_cvt_pk_bf16_f32 v137, v138, v139
  v_exp_f32 v141, v141
  v_exp_f32 v142, v142
  v_cvt_pk_bf16_f32 v138, v140, v141
  v_exp_f32 v143, v143
  v_exp_f32 v144, v144
  v_cvt_pk_bf16_f32 v139, v142, v143
  s_nop 1
  v_mfma_f32_16x16x32_bf16 v[208:211], a[192:195], v[136:139], v[208:211]
  v_exp_f32 v145, v145
  v_exp_f32 v146, v146
  v_cvt_pk_bf16_f32 v144, v144, v145
  v_exp_f32 v147, v147
  v_exp_f32 v148, v148
  v_cvt_pk_bf16_f32 v145, v146, v147
  v_exp_f32 v149, v149
  v_exp_f32 v150, v150
  v_cvt_pk_bf16_f32 v146, v148, v149
  v_exp_f32 v151, v151
  v_exp_f32 v152, v152
  v_cvt_pk_bf16_f32 v147, v150, v151
  s_nop 1
  v_mfma_f32_16x16x32_bf16 v[212:215], a[192:195], v[144:147], 0
  v_exp_f32 v153, v153
  v_exp_f32 v154, v154
  v_cvt_pk_bf16_f32 v152, v152, v153
  v_exp_f32 v155, v155
  v_exp_f32 v156, v156
  v_cvt_pk_bf16_f32 v153, v154, v155
  v_exp_f32 v157, v157
  v_exp_f32 v158, v158
  v_cvt_pk_bf16_f32 v154, v156, v157
  v_exp_f32 v159, v159
  s_nop 0
  v_cvt_pk_bf16_f32 v155, v158, v159
  s_nop 1
  v_mfma_f32_16x16x32_bf16 v[212:215], a[192:195], v[152:155], v[212:215]
  s_nop 7
  s_branch L_slow_2_ret
L_slow_3:
  s_nop 3
  v_xor_b32 v224, 0x8000, v224
  v_xor_b32 v225, 0x8000, v225
  v_xor_b32 v226, 0x8000, v226
  v_xor_b32 v227, 0x8000, v227
  ds_read_b128 a[64:67], v224 offset:16384
  ds_read_b128 a[68:71], v225 offset:16384
  ds_read_b128 a[72:75], v226 offset:16384
  ds_read_b128 a[76:79], v227 offset:16384
  ds_read_b128 a[80:83], v224 offset:20480
  ds_read_b128 a[84:87], v225 offset:20480
  ds_read_b128 a[88:91], v226 offset:20480
  ds_read_b128 a[92:95], v227 offset:20480
  ds_read_b128 a[96:99], v224 offset:24576
  ds_read_b128 a[100:103], v225 offset:24576
  ds_read_b128 a[104:107], v226 offset:24576
  ds_read_b128 a[108:111], v227 offset:24576
  ds_read_b128 a[112:115], v224 offset:28672
  ds_read_b128 a[116:119], v225 offset:28672
  ds_read_b128 a[120:123], v226 offset:28672
  ds_read_b128 a[124:127], v227 offset:28672
  v_xor_b32 v224, 0x8000, v224
  v_xor_b32 v225, 0x8000, v225
  v_xor_b32 v226, 0x8000, v226
  v_xor_b32 v227, 0x8000, v227
  s_waitcnt lgkmcnt(0)
  v_mfma_f32_16x16x32_bf16 v[160:163], a[64:67], a[32:35], v[200:203]
  v_mfma_f32_16x16x32_bf16 v[160:163], a[68:71], a[36:39], v[160:163]
  v_mfma_f32_16x16x32_bf16 v[160:163], a[72:75], a[40:43], v[160:163]
  v_mfma_f32_16x16x32_bf16 v[160:163], a[76:79], a[44:47], v[160:163]
  v_mfma_f32_16x16x32_bf16 v[176:179], a[76:79], a[60:63], v[204:207]
  v_mfma_f32_16x16x32_bf16 v[176:179], a[72:75], a[56:59], v[176:179]
  v_mfma_f32_16x16x32_bf16 v[176:179], a[68:71], a[52:55], v[176:179]
  v_mfma_f32_16x16x32_bf16 v[176:179], a[64:67], a[48:51], v[176:179]
  v_mfma_f32_16x16x32_bf16 v[180:183], a[80:83], a[48:51], v[204:207]
  v_mfma_f32_16x16x32_bf16 v[180:183], a[84:87], a[52:55], v[180:183]
  v_mfma_f32_16x16x32_bf16 v[180:183], a[88:91], a[56:59], v[180:183]
  v_mfma_f32_16x16x32_bf16 v[180:183], a[92:95], a[60:63], v[180:183]
  v_mfma_f32_16x16x32_bf16 v[164:167], a[92:95], a[44:47], v[200:203]
  v_mfma_f32_16x16x32_bf16 v[164:167], a[88:91], a[40:43], v[164:167]
  v_mfma_f32_16x16x32_bf16 v[164:167], a[84:87], a[36:39], v[164:167]
  v_mfma_f32_16x16x32_bf16 v[164:167], a[80:83], a[32:35], v[164:167]
  v_mfma_f32_16x16x32_bf16 v[168:171], a[96:99], a[32:35], v[200:203]
  v_mfma_f32_16x16x32_bf16 v[168:171], a[100:103], a[36:39], v[168:171]
  v_mfma_f32_16x16x32_bf16 v[168:171], a[104:107], a[40:43], v[168:171]
  v_mfma_f32_16x16x32_bf16 v[168:171], a[108:111], a[44:47], v[168:171]
  v_mfma_f32_16x16x32_bf16 v[184:187], a[108:111], a[60:63], v[204:207]
  v_mfma_f32_16x16x32_bf16 v[184:187], a[104:107], a[56:59], v[184:187]
  v_mfma_f32_16x16x32_bf16 v[184:187], a[100:103], a[52:55], v[184:187]
  v_mfma_f32_16x16x32_bf16 v[184:187], a[96:99], a[48:51], v[184:187]
  v_mfma_f32_16x16x32_bf16 v[188:191], a[112:115], a[48:51], v[204:207]
  v_mfma_f32_16x16x32_bf16 v[188:191], a[116:119], a[52:55], v[188:191]
  v_mfma_f32_16x16x32_bf16 v[188:191], a[120:123], a[56:59], v[188:191]
  v_mfma_f32_16x16x32_bf16 v[188:191], a[124:127], a[60:63], v[188:191]
  v_mfma_f32_16x16x32_bf16 v[172:175], a[124:127], a[44:47], v[200:203]
  v_mfma_f32_16x16x32_bf16 v[172:175], a[120:123], a[40:43], v[172:175]
  v_mfma_f32_16x16x32_bf16 v[172:175], a[116:119], a[36:39], v[172:175]
  v_mfma_f32_16x16x32_bf16 v[172:175], a[112:115], a[32:35], v[172:175]
  s_nop 7
  ds_read_b128 a[64:67], v224 offset:0
  ds_read_b128 a[68:71], v225 offset:0
  ds_read_b128 a[72:75], v226 offset:0
  ds_read_b128 a[76:79], v227 offset:0
  ds_read_b128 a[80:83], v224 offset:4096
  ds_read_b128 a[84:87], v225 offset:4096
  ds_read_b128 a[88:91], v226 offset:4096
  ds_read_b128 a[92:95], v227 offset:4096
  ds_read_b128 a[96:99], v224 offset:8192
  ds_read_b128 a[100:103], v225 offset:8192
  ds_read_b128 a[104:107], v226 offset:8192
  ds_read_b128 a[108:111], v227 offset:8192
  ds_read_b128 a[112:115], v224 offset:12288
  ds_read_b128 a[116:119], v225 offset:12288
  ds_read_b128 a[120:123], v226 offset:12288
  ds_read_b128 a[124:127], v227 offset:12288
  v_max3_f32 v246, v160, v161, v162
  v_max3_f32 v247, v163, v164, v165
  v_max3_f32 v246, v246, v166, v167
  v_max3_f32 v247, v247, v168, v169
  v_max3_f32 v246, v246, v170, v171
  v_max3_f32 v247, v247, v172, v173
  v_max3_f32 v246, v246, v174, v175
  v_max_f32 v246, v246, v247
  v_mov_b32 v247, v246
  s_nop 1
  v_permlane16_swap_b32 v246, v247
  s_nop 1
  v_max_f32 v246, v246, v247
  v_mov_b32 v247, v246
  s_nop 1
  v_permlane32_swap_b32 v246, v247
  s_nop 1
  v_max_f32 v246, v246, v247
  v_max_f32 v246, 0, v246
  v_exp_f32 v248, -v246
  v_sub_f32 v200, v200, v246
  v_sub_f32 v201, v201, v246
  v_sub_f32 v202, v202, v246
  v_sub_f32 v203, v203, v246
  v_mul_f32 v244, v244, v248
  ds_bpermute_b32 v252, v240, v248 offset:0
  ds_bpermute_b32 v253, v240, v248 offset:4
  ds_bpermute_b32 v254, v240, v248 offset:8
  ds_bpermute_b32 v255, v240, v248 offset:12
  v_sub_f32 v160, v160, v246
  v_sub_f32 v161, v161, v246
  v_sub_f32 v162, v162, v246
  v_sub_f32 v163, v163, v246
  v_sub_f32 v164, v164, v246
  v_sub_f32 v165, v165, v246
  v_sub_f32 v166, v166, v246
  v_sub_f32 v167, v167, v246
  v_sub_f32 v168, v168, v246
  v_sub_f32 v169, v169, v246
  v_sub_f32 v170, v170, v246
  v_sub_f32 v171, v171, v246
  v_sub_f32 v172, v172, v246
  v_sub_f32 v173, v173, v246
  v_sub_f32 v174, v174, v246
  v_sub_f32 v175, v175, v246
  s_waitcnt lgkmcnt(0)
  v_mul_f32 v64, v64, v252
  v_mul_f32 v65, v65, v253
  v_mul_f32 v66, v66, v254
  v_mul_f32 v67, v67, v255
  v_mul_f32 v68, v68, v252
  v_mul_f32 v69, v69, v253
  v_mul_f32 v70, v70, v254
  v_mul_f32 v71, v71, v255
  v_mul_f32 v72, v72, v252
  v_mul_f32 v73, v73, v253
  v_mul_f32 v74, v74, v254
  v_mul_f32 v75, v75, v255
  v_mul_f32 v76, v76, v252
  v_mul_f32 v77, v77, v253
  v_mul_f32 v78, v78, v254
  v_mul_f32 v79, v79, v255
  v_mul_f32 v80, v80, v252
  v_mul_f32 v81, v81, v253
  v_mul_f32 v82, v82, v254
  v_mul_f32 v83, v83, v255
  v_mul_f32 v84, v84, v252
  v_mul_f32 v85, v85, v253
  v_mul_f32 v86, v86, v254
  v_mul_f32 v87, v87, v255
  v_mul_f32 v88, v88, v252
  v_mul_f32 v89, v89, v253
  v_mul_f32 v90, v90, v254
  v_mul_f32 v91, v91, v255
  v_mul_f32 v92, v92, v252
  v_mul_f32 v93, v93, v253
  v_mul_f32 v94, v94, v254
  v_mul_f32 v95, v95, v255
  v_max3_f32 v246, v176, v177, v178
  v_max3_f32 v247, v179, v180, v181
  v_max3_f32 v246, v246, v182, v183
  v_max3_f32 v247, v247, v184, v185
  v_max3_f32 v246, v246, v186, v187
  v_max3_f32 v247, v247, v188, v189
  v_max3_f32 v246, v246, v190, v191
  v_max_f32 v246, v246, v247
  v_mov_b32 v247, v246
  s_nop 1
  v_permlane16_swap_b32 v246, v247
  s_nop 1
  v_max_f32 v246, v246, v247
  v_mov_b32 v247, v246
  s_nop 1
  v_permlane32_swap_b32 v246, v247
  s_nop 1
  v_max_f32 v246, v246, v247
  v_max_f32 v246, 0, v246
  v_exp_f32 v248, -v246
  v_sub_f32 v204, v204, v246
  v_sub_f32 v205, v205, v246
  v_sub_f32 v206, v206, v246
  v_sub_f32 v207, v207, v246
  v_mul_f32 v245, v245, v248
  ds_bpermute_b32 v252, v240, v248 offset:0
  ds_bpermute_b32 v253, v240, v248 offset:4
  ds_bpermute_b32 v254, v240, v248 offset:8
  ds_bpermute_b32 v255, v240, v248 offset:12
  v_sub_f32 v176, v176, v246
  v_sub_f32 v177, v177, v246
  v_sub_f32 v178, v178, v246
  v_sub_f32 v179, v179, v246
  v_sub_f32 v180, v180, v246
  v_sub_f32 v181, v181, v246
  v_sub_f32 v182, v182, v246
  v_sub_f32 v183, v183, v246
  v_sub_f32 v184, v184, v246
  v_sub_f32 v185, v185, v246
  v_sub_f32 v186, v186, v246
  v_sub_f32 v187, v187, v246
  v_sub_f32 v188, v188, v246
  v_sub_f32 v189, v189, v246
  v_sub_f32 v190, v190, v246
  v_sub_f32 v191, v191, v246
  s_waitcnt lgkmcnt(0)
  v_mul_f32 v96, v96, v252
  v_mul_f32 v97, v97, v253
  v_mul_f32 v98, v98, v254
  v_mul_f32 v99, v99, v255
  v_mul_f32 v100, v100, v252
  v_mul_f32 v101, v101, v253
  v_mul_f32 v102, v102, v254
  v_mul_f32 v103, v103, v255
  v_mul_f32 v104, v104, v252
  v_mul_f32 v105, v105, v253
  v_mul_f32 v106, v106, v254
  v_mul_f32 v107, v107, v255
  v_mul_f32 v108, v108, v252
  v_mul_f32 v109, v109, v253
  v_mul_f32 v110, v110, v254
  v_mul_f32 v111, v111, v255
  v_mul_f32 v112, v112, v252
  v_mul_f32 v113, v113, v253
  v_mul_f32 v114, v114, v254
  v_mul_f32 v115, v115, v255
  v_mul_f32 v116, v116, v252
  v_mul_f32 v117, v117, v253
  v_mul_f32 v118, v118, v254
  v_mul_f32 v119, v119, v255
  v_mul_f32 v120, v120, v252
  v_mul_f32 v121, v121, v253
  v_mul_f32 v122, v122, v254
  v_mul_f32 v123, v123, v255
  v_mul_f32 v124, v124, v252
  v_mul_f32 v125, v125, v253
  v_mul_f32 v126, v126, v254
  v_mul_f32 v127, v127, v255
  v_exp_f32 v160, v160
  v_exp_f32 v161, v161
  v_exp_f32 v162, v162
  v_cvt_pk_bf16_f32 v160, v160, v161
  v_exp_f32 v163, v163
  v_exp_f32 v164, v164
  v_cvt_pk_bf16_f32 v161, v162, v163
  v_exp_f32 v165, v165
  v_exp_f32 v166, v166
  v_cvt_pk_bf16_f32 v162, v164, v165
  v_exp_f32 v167, v167
  v_exp_f32 v168, v168
  v_cvt_pk_bf16_f32 v163, v166, v167
  s_nop 1
  v_mfma_f32_16x16x32_bf16 v[216:219], a[192:195], v[160:163], 0
  v_exp_f32 v169, v169
  v_exp_f32 v170, v170
  v_cvt_pk_bf16_f32 v168, v168, v169
  v_exp_f32 v171, v171
  v_exp_f32 v172, v172
  v_cvt_pk_bf16_f32 v169, v170, v171
  v_exp_f32 v173, v173
  v_exp_f32 v174, v174
  v_cvt_pk_bf16_f32 v170, v172, v173
  v_exp_f32 v175, v175
  v_exp_f32 v176, v176
  v_cvt_pk_bf16_f32 v171, v174, v175
  s_nop 1
  v_mfma_f32_16x16x32_bf16 v[216:219], a[192:195], v[168:171], v[216:219]
  v_exp_f32 v177, v177
  v_exp_f32 v178, v178
  v_cvt_pk_bf16_f32 v176, v176, v177
  v_exp_f32 v179, v179
  v_exp_f32 v180, v180
  v_cvt_pk_bf16_f32 v177, v178, v179
  v_exp_f32 v181, v181
  v_exp_f32 v182, v182
  v_cvt_pk_bf16_f32 v178, v180, v181
  v_exp_f32 v183, v183
  v_exp_f32 v184, v184
  v_cvt_pk_bf16_f32 v179, v182, v183
  s_nop 1
  v_mfma_f32_16x16x32_bf16 v[220:223], a[192:195], v[176:179], 0
  v_exp_f32 v185, v185
  v_exp_f32 v186, v186
  v_cvt_pk_bf16_f32 v184, v184, v185
  v_exp_f32 v187, v187
  v_exp_f32 v188, v188
  v_cvt_pk_bf16_f32 v185, v186, v187
  v_exp_f32 v189, v189
  v_exp_f32 v190, v190
  v_cvt_pk_bf16_f32 v186, v188, v189
  v_exp_f32 v191, v191
  s_nop 0
  v_cvt_pk_bf16_f32 v187, v190, v191
  s_nop 1
  v_mfma_f32_16x16x32_bf16 v[220:223], a[192:195], v[184:187], v[220:223]
  s_nop 7
  s_branch L_slow_3_ret
L_slow_0:
  s_nop 3
  s_waitcnt lgkmcnt(0)
  v_mfma_f32_16x16x32_bf16 v[128:131], a[64:67], a[0:3], v[192:195]
  v_mfma_f32_16x16x32_bf16 v[128:131], a[68:71], a[4:7], v[128:131]
  v_mfma_f32_16x16x32_bf16 v[128:131], a[72:75], a[8:11], v[128:131]
  v_mfma_f32_16x16x32_bf16 v[128:131], a[76:79], a[12:15], v[128:131]
  v_mfma_f32_16x16x32_bf16 v[144:147], a[76:79], a[28:31], v[196:199]
  v_mfma_f32_16x16x32_bf16 v[144:147], a[72:75], a[24:27], v[144:147]
  v_mfma_f32_16x16x32_bf16 v[144:147], a[68:71], a[20:23], v[144:147]
  v_mfma_f32_16x16x32_bf16 v[144:147], a[64:67], a[16:19], v[144:147]
  v_mfma_f32_16x16x32_bf16 v[148:151], a[80:83], a[16:19], v[196:199]
  v_mfma_f32_16x16x32_bf16 v[148:151], a[84:87], a[20:23], v[148:151]
  v_mfma_f32_16x16x32_bf16 v[148:151], a[88:91], a[24:27], v[148:151]
  v_mfma_f32_16x16x32_bf16 v[148:151], a[92:95], a[28:31], v[148:151]
  v_mfma_f32_16x16x32_bf16 v[132:135], a[92:95], a[12:15], v[192:195]
  v_mfma_f32_16x16x32_bf16 v[132:135], a[88:91], a[8:11], v[132:135]
  v_mfma_f32_16x16x32_bf16 v[132:135], a[84:87], a[4:7], v[132:135]
  v_mfma_f32_16x16x32_bf16 v[132:135], a[80:83], a[0:3], v[132:135]
  v_mfma_f32_16x16x32_bf16 v[136:139], a[96:99], a[0:3], v[192:195]
  v_mfma_f32_16x16x32_bf16 v[136:139], a[100:103], a[4:7], v[136:139]
  v_mfma_f32_16x16x32_bf16 v[136:139], a[104:107], a[8:11], v[136:139]
  v_mfma_f32_16x16x32_bf16 v[136:139], a[108:111], a[12:15], v[136:139]
  v_mfma_f32_16x16x32_bf16 v[152:155], a[108:111], a[28:31], v[196:199]
  v_mfma_f32_16x16x32_bf16 v[152:155], a[104:107], a[24:27], v[152:155]
  v_mfma_f32_16x16x32_bf16 v[152:155], a[100:103], a[20:23], v[152:155]
  v_mfma_f32_16x16x32_bf16 v[152:155], a[96:99], a[16:19], v[152:155]
  v_mfma_f32_16x16x32_bf16 v[156:159], a[112:115], a[16:19], v[196:199]
  v_mfma_f32_16x16x32_bf16 v[156:159], a[116:119], a[20:23], v[156:159]
  v_mfma_f32_16x16x32_bf16 v[156:159], a[120:123], a[24:27], v[156:159]
  v_mfma_f32_16x16x32_bf16 v[156:159], a[124:127], a[28:31], v[156:159]
  v_mfma_f32_16x16x32_bf16 v[140:143], a[124:127], a[12:15], v[192:195]
  v_mfma_f32_16x16x32_bf16 v[140:143], a[120:123], a[8:11], v[140:143]
  v_mfma_f32_16x16x32_bf16 v[140:143], a[116:119], a[4:7], v[140:143]
  v_mfma_f32_16x16x32_bf16 v[140:143], a[112:115], a[0:3], v[140:143]
  s_nop 7
  v_max3_f32 v246, v128, v129, v130
  v_max3_f32 v247, v131, v132, v133
  v_max3_f32 v246, v246, v134, v135
  v_max3_f32 v247, v247, v136, v137
  v_max3_f32 v246, v246, v138, v139
  v_max3_f32 v247, v247, v140, v141
  v_max3_f32 v246, v246, v142, v143
  v_max_f32 v246, v246, v247
  v_mov_b32 v247, v246
  s_nop 1
  v_permlane16_swap_b32 v246, v247
  s_nop 1
  v_max_f32 v246, v246, v247
  v_mov_b32 v247, v246
  s_nop 1
  v_permlane32_swap_b32 v246, v247
  s_nop 1
  v_max_f32 v246, v246, v247
  v_max_f32 v246, 0, v246
  v_exp_f32 v248, -v246
  v_sub_f32 v192, v192, v246
  v_sub_f32 v193, v193, v246
  v_sub_f32 v194, v194, v246
  v_sub_f32 v195, v195, v246
  v_mul_f32 v242, v242, v248
  ds_bpermute_b32 v252, v240, v248 offset:0
  ds_bpermute_b32 v253, v240, v248 offset:4
  ds_bpermute_b32 v254, v240, v248 offset:8
  ds_bpermute_b32 v255, v240, v248 offset:12
  v_sub_f32 v128, v128, v246
  v_sub_f32 v129, v129, v246
  v_sub_f32 v130, v130, v246
  v_sub_f32 v131, v131, v246
  v_sub_f32 v132, v132, v246
  v_sub_f32 v133, v133, v246
  v_sub_f32 v134, v134, v246
  v_sub_f32 v135, v135, v246
  v_sub_f32 v136, v136, v246
  v_sub_f32 v137, v137, v246
  v_sub_f32 v138, v138, v246
  v_sub_f32 v139, v139, v246
  v_sub_f32 v140, v140, v246
  v_sub_f32 v141, v141, v246
  v_sub_f32 v142, v142, v246
  v_sub_f32 v143, v143, v246
  s_waitcnt lgkmcnt(0)
  v_mul_f32 v0, v0, v252
  v_mul_f32 v1, v1, v253
  v_mul_f32 v2, v2, v254
  v_mul_f32 v3, v3, v255
  v_mul_f32 v4, v4, v252
  v_mul_f32 v5, v5, v253
  v_mul_f32 v6, v6, v254
  v_mul_f32 v7, v7, v255
  v_mul_f32 v8, v8, v252
  v_mul_f32 v9, v9, v253
  v_mul_f32 v10, v10, v254
  v_mul_f32 v11, v11, v255
  v_mul_f32 v12, v12, v252
  v_mul_f32 v13, v13, v253
  v_mul_f32 v14, v14, v254
  v_mul_f32 v15, v15, v255
  v_mul_f32 v16, v16, v252
  v_mul_f32 v17, v17, v253
  v_mul_f32 v18, v18, v254
  v_mul_f32 v19, v19, v255
  v_mul_f32 v20, v20, v252
  v_mul_f32 v21, v21, v253
  v_mul_f32 v22, v22, v254
  v_mul_f32 v23, v23, v255
  v_mul_f32 v24, v24, v252
  v_mul_f32 v25, v25, v253
  v_mul_f32 v26, v26, v254
  v_mul_f32 v27, v27, v255
  v_mul_f32 v28, v28, v252
  v_mul_f32 v29, v29, v253
  v_mul_f32 v30, v30, v254
  v_mul_f32 v31, v31, v255
  v_max3_f32 v246, v144, v145, v146
  v_max3_f32 v247, v147, v148, v149
  v_max3_f32 v246, v246, v150, v151
  v_max3_f32 v247, v247, v152, v153
  v_max3_f32 v246, v246, v154, v155
  v_max3_f32 v247, v247, v156, v157
  v_max3_f32 v246, v246, v158, v159
  v_max_f32 v246, v246, v247
  v_mov_b32 v247, v246
  s_nop 1
  v_permlane16_swap_b32 v246, v247
  s_nop 1
  v_max_f32 v246, v246, v247
  v_mov_b32 v247, v246
  s_nop 1
  v_permlane32_swap_b32 v246, v247
  s_nop 1
  v_max_f32 v246, v246, v247
  v_max_f32 v246, 0, v246
  v_exp_f32 v248, -v246
  v_sub_f32 v196, v196, v246
  v_sub_f32 v197, v197, v246
  v_sub_f32 v198, v198, v246
  v_sub_f32 v199, v199, v246
  v_mul_f32 v243, v243, v248
  ds_bpermute_b32 v252, v240, v248 offset:0
  ds_bpermute_b32 v253, v240, v248 offset:4
  ds_bpermute_b32 v254, v240, v248 offset:8
  ds_bpermute_b32 v255, v240, v248 offset:12
  v_sub_f32 v144, v144, v246
  v_sub_f32 v145, v145, v246
  v_sub_f32 v146, v146, v246
  v_sub_f32 v147, v147, v246
  v_sub_f32 v148, v148, v246
  v_sub_f32 v149, v149, v246
  v_sub_f32 v150, v150, v246
  v_sub_f32 v151, v151, v246
  v_sub_f32 v152, v152, v246
  v_sub_f32 v153, v153, v246
  v_sub_f32 v154, v154, v246
  v_sub_f32 v155, v155, v246
  v_sub_f32 v156, v156, v246
  v_sub_f32 v157, v157, v246
  v_sub_f32 v158, v158, v246
  v_sub_f32 v159, v159, v246
  s_waitcnt lgkmcnt(0)
  v_mul_f32 v32, v32, v252
  v_mul_f32 v33, v33, v253
  v_mul_f32 v34, v34, v254
  v_mul_f32 v35, v35, v255
  v_mul_f32 v36, v36, v252
  v_mul_f32 v37, v37, v253
  v_mul_f32 v38, v38, v254
  v_mul_f32 v39, v39, v255
  v_mul_f32 v40, v40, v252
  v_mul_f32 v41, v41, v253
  v_mul_f32 v42, v42, v254
  v_mul_f32 v43, v43, v255
  v_mul_f32 v44, v44, v252
  v_mul_f32 v45, v45, v253
  v_mul_f32 v46, v46, v254
  v_mul_f32 v47, v47, v255
  v_mul_f32 v48, v48, v252
  v_mul_f32 v49, v49, v253
  v_mul_f32 v50, v50, v254
  v_mul_f32 v51, v51, v255
  v_mul_f32 v52, v52, v252
  v_mul_f32 v53, v53, v253
  v_mul_f32 v54, v54, v254
  v_mul_f32 v55, v55, v255
  v_mul_f32 v56, v56, v252
  v_mul_f32 v57, v57, v253
  v_mul_f32 v58, v58, v254
  v_mul_f32 v59, v59, v255
  v_mul_f32 v60, v60, v252
  v_mul_f32 v61, v61, v253
  v_mul_f32 v62, v62, v254
  v_mul_f32 v63, v63, v255
  v_exp_f32 v128, v128
  v_exp_f32 v129, v129
  v_exp_f32 v130, v130
  v_cvt_pk_bf16_f32 v128, v128, v129
  v_exp_f32 v131, v131
  v_exp_f32 v132, v132
  v_cvt_pk_bf16_f32 v129, v130, v131
  v_exp_f32 v133, v133
  v_exp_f32 v134, v134
  v_cvt_pk_bf16_f32 v130, v132, v133
  v_exp_f32 v135, v135
  v_exp_f32 v136, v136
  v_cvt_pk_bf16_f32 v131, v134, v135
  s_nop 1
  v_mfma_f32_16x16x32_bf16 v[208:211], a[192:195], v[128:131], 0
  v_exp_f32 v137, v137
  v_exp_f32 v138, v138
  v_cvt_pk_bf16_f32 v136, v136, v137
  v_exp_f32 v139, v139
  v_exp_f32 v140, v140
  v_cvt_pk_bf16_f32 v137, v138, v139
  v_exp_f32 v141, v141
  v_exp_f32 v142, v142
  v_cvt_pk_bf16_f32 v138, v140, v141
  v_exp_f32 v143, v143
  v_exp_f32 v144, v144
  v_cvt_pk_bf16_f32 v139, v142, v143
  s_nop 1
  v_mfma_f32_16x16x32_bf16 v[208:211], a[192:195], v[136:139], v[208:211]
  v_exp_f32 v145, v145
  v_exp_f32 v146, v146
  v_cvt_pk_bf16_f32 v144, v144, v145
  v_exp_f32 v147, v147
  v_exp_f32 v148, v148
  v_cvt_pk_bf16_f32 v145, v146, v147
  v_exp_f32 v149, v149
  v_exp_f32 v150, v150
  v_cvt_pk_bf16_f32 v146, v148, v149
  v_exp_f32 v151, v151
  v_exp_f32 v152, v152
  v_cvt_pk_bf16_f32 v147, v150, v151
  s_nop 1
  v_mfma_f32_16x16x32_bf16 v[212:215], a[192:195], v[144:147], 0
  v_exp_f32 v153, v153
  v_exp_f32 v154, v154
  v_cvt_pk_bf16_f32 v152, v152, v153
  v_exp_f32 v155, v155
  v_exp_f32 v156, v156
  v_cvt_pk_bf16_f32 v153, v154, v155
  v_exp_f32 v157, v157
  v_exp_f32 v158, v158
  v_cvt_pk_bf16_f32 v154, v156, v157
  v_exp_f32 v159, v159
  s_nop 0
  v_cvt_pk_bf16_f32 v155, v158, v159
  s_nop 1
  v_mfma_f32_16x16x32_bf16 v[212:215], a[192:195], v[152:155], v[212:215]
  s_nop 7
  s_branch L_slow_0_ret
L_slow_1:
  s_nop 3
  v_xor_b32 v224, 0x8000, v224
  v_xor_b32 v225, 0x8000, v225
  v_xor_b32 v226, 0x8000, v226
  v_xor_b32 v227, 0x8000, v227
  ds_read_b128 a[64:67], v224 offset:0
  ds_read_b128 a[68:71], v225 offset:0
  ds_read_b128 a[72:75], v226 offset:0
  ds_read_b128 a[76:79], v227 offset:0
  ds_read_b128 a[80:83], v224 offset:4096
  ds_read_b128 a[84:87], v225 offset:4096
  ds_read_b128 a[88:91], v226 offset:4096
  ds_read_b128 a[92:95], v227 offset:4096
  ds_read_b128 a[96:99], v224 offset:8192
  ds_read_b128 a[100:103], v225 offset:8192
  ds_read_b128 a[104:107], v226 offset:8192
  ds_read_b128 a[108:111], v227 offset:8192
  ds_read_b128 a[112:115], v224 offset:12288
  ds_read_b128 a[116:119], v225 offset:12288
  ds_read_b128 a[120:123], v226 offset:12288
  ds_read_b128 a[124:127], v227 offset:12288
  v_xor_b32 v224, 0x8000, v224
  v_xor_b32 v225, 0x8000, v225
  v_xor_b32 v226, 0x8000, v226
  v_xor_b32 v227, 0x8000, v227
  s_waitcnt lgkmcnt(0)
  v_mfma_f32_16x16x32_bf16 v[160:163], a[64:67], a[32:35], v[200:203]
  v_mfma_f32_16x16x32_bf16 v[160:163], a[68:71], a[36:39], v[160:163]
  v_mfma_f32_16x16x32_bf16 v[160:163], a[72:75], a[40:43], v[160:163]
  v_mfma_f32_16x16x32_bf16 v[160:163], a[76:79], a[44:47], v[160:163]
  v_mfma_f32_16x16x32_bf16 v[176:179], a[76:79], a[60:63], v[204:207]
  v_mfma_f32_16x16x32_bf16 v[176:179], a[72:75], a[56:59], v[176:179]
  v_mfma_f32_16x16x32_bf16 v[176:179], a[68:71], a[52:55], v[176:179]
  v_mfma_f32_16x16x32_bf16 v[176:179], a[64:67], a[48:51], v[176:179]
  v_mfma_f32_16x16x32_bf16 v[180:183], a[80:83], a[48:51], v[204:207]
  v_mfma_f32_16x16x32_bf16 v[180:183], a[84:87], a[52:55], v[180:183]
  v_mfma_f32_16x16x32_bf16 v[180:183], a[88:91], a[56:59], v[180:183]
  v_mfma_f32_16x16x32_bf16 v[180:183], a[92:95], a[60:63], v[180:183]
  v_mfma_f32_16x16x32_bf16 v[164:167], a[92:95], a[44:47], v[200:203]
  v_mfma_f32_16x16x32_bf16 v[164:167], a[88:91], a[40:43], v[164:167]
  v_mfma_f32_16x16x32_bf16 v[164:167], a[84:87], a[36:39], v[164:167]
  v_mfma_f32_16x16x32_bf16 v[164:167], a[80:83], a[32:35], v[164:167]
  v_mfma_f32_16x16x32_bf16 v[168:171], a[96:99], a[32:35], v[200:203]
  v_mfma_f32_16x16x32_bf16 v[168:171], a[100:103], a[36:39], v[168:171]
  v_mfma_f32_16x16x32_bf16 v[168:171], a[104:107], a[40:43], v[168:171]
  v_mfma_f32_16x16x32_bf16 v[168:171], a[108:111], a[44:47], v[168:171]
  v_mfma_f32_16x16x32_bf16 v[184:187], a[108:111], a[60:63], v[204:207]
  v_mfma_f32_16x16x32_bf16 v[184:187], a[104:107], a[56:59], v[184:187]
  v_mfma_f32_16x16x32_bf16 v[184:187], a[100:103], a[52:55], v[184:187]
  v_mfma_f32_16x16x32_bf16 v[184:187], a[96:99], a[48:51], v[184:187]
  v_mfma_f32_16x16x32_bf16 v[188:191], a[112:115], a[48:51], v[204:207]
  v_mfma_f32_16x16x32_bf16 v[188:191], a[116:119], a[52:55], v[188:191]
  v_mfma_f32_16x16x32_bf16 v[188:191], a[120:123], a[56:59], v[188:191]
  v_mfma_f32_16x16x32_bf16 v[188:191], a[124:127], a[60:63], v[188:191]
  v_mfma_f32_16x16x32_bf16 v[172:175], a[124:127], a[44:47], v[200:203]
  v_mfma_f32_16x16x32_bf16 v[172:175], a[120:123], a[40:43], v[172:175]
  v_mfma_f32_16x16x32_bf16 v[172:175], a[116:119], a[36:39], v[172:175]
  v_mfma_f32_16x16x32_bf16 v[172:175], a[112:115], a[32:35], v[172:175]
  s_nop 7
  v_xor_b32 v224, 0x8000, v224
  v_xor_b32 v225, 0x8000, v225
  v_xor_b32 v226, 0x8000, v226
  v_xor_b32 v227, 0x8000, v227
  ds_read_b128 a[64:67], v224 offset:16384
  ds_read_b128 a[68:71], v225 offset:16384
  ds_read_b128 a[72:75], v226 offset:16384
  ds_read_b128 a[76:79], v227 offset:16384
  ds_read_b128 a[80:83], v224 offset:20480
  ds_read_b128 a[84:87], v225 offset:20480
  ds_read_b128 a[88:91], v226 offset:20480
  ds_read_b128 a[92:95], v227 offset:20480
  ds_read_b128 a[96:99], v224 offset:24576
  ds_read_b128 a[100:103], v225 offset:24576
  ds_read_b128 a[104:107], v226 offset:24576
  ds_read_b128 a[108:111], v227 offset:24576
  ds_read_b128 a[112:115], v224 offset:28672
  ds_read_b128 a[116:119], v225 offset:28672
  ds_read_b128 a[120:123], v226 offset:28672
  ds_read_b128 a[124:127], v227 offset:28672
  v_xor_b32 v224, 0x8000, v224
  v_xor_b32 v225, 0x8000, v225
  v_xor_b32 v226, 0x8000, v226
  v_xor_b32 v227, 0x8000, v227
  v_max3_f32 v246, v160, v161, v162
  v_max3_f32 v247, v163, v164, v165
  v_max3_f32 v246, v246, v166, v167
  v_max3_f32 v247, v247, v168, v169
  v_max3_f32 v246, v246, v170, v171
  v_max3_f32 v247, v247, v172, v173
  v_max3_f32 v246, v246, v174, v175
  v_max_f32 v246, v246, v247
  v_mov_b32 v247, v246
  s_nop 1
  v_permlane16_swap_b32 v246, v247
  s_nop 1
  v_max_f32 v246, v246, v247
  v_mov_b32 v247, v246
  s_nop 1
  v_permlane32_swap_b32 v246, v247
  s_nop 1
  v_max_f32 v246, v246, v247
  v_max_f32 v246, 0, v246
  v_exp_f32 v248, -v246
  v_sub_f32 v200, v200, v246
  v_sub_f32 v201, v201, v246
  v_sub_f32 v202, v202, v246
  v_sub_f32 v203, v203, v246
  v_mul_f32 v244, v244, v248
  ds_bpermute_b32 v252, v240, v248 offset:0
  ds_bpermute_b32 v253, v240, v248 offset:4
  ds_bpermute_b32 v254, v240, v248 offset:8
  ds_bpermute_b32 v255, v240, v248 offset:12
  v_sub_f32 v160, v160, v246
  v_sub_f32 v161, v161, v246
  v_sub_f32 v162, v162, v246
  v_sub_f32 v163, v163, v246
  v_sub_f32 v164, v164, v246
  v_sub_f32 v165, v165, v246
  v_sub_f32 v166, v166, v246
  v_sub_f32 v167, v167, v246
  v_sub_f32 v168, v168, v246
  v_sub_f32 v169, v169, v246
  v_sub_f32 v170, v170, v246
  v_sub_f32 v171, v171, v246
  v_sub_f32 v172, v172, v246
  v_sub_f32 v173, v173, v246
  v_sub_f32 v174, v174, v246
  v_sub_f32 v175, v175, v246
  s_waitcnt lgkmcnt(0)
  v_mul_f32 v64, v64, v252
  v_mul_f32 v65, v65, v253
  v_mul_f32 v66, v66, v254
  v_mul_f32 v67, v67, v255
  v_mul_f32 v68, v68, v252
  v_mul_f32 v69, v69, v253
  v_mul_f32 v70, v70, v254
  v_mul_f32 v71, v71, v255
  v_mul_f32 v72, v72, v252
  v_mul_f32 v73, v73, v253
  v_mul_f32 v74, v74, v254
  v_mul_f32 v75, v75, v255
  v_mul_f32 v76, v76, v252
  v_mul_f32 v77, v77, v253
  v_mul_f32 v78, v78, v254
  v_mul_f32 v79, v79, v255
  v_mul_f32 v80, v80, v252
  v_mul_f32 v81, v81, v253
  v_mul_f32 v82, v82, v254
  v_mul_f32 v83, v83, v255
  v_mul_f32 v84, v84, v252
  v_mul_f32 v85, v85, v253
  v_mul_f32 v86, v86, v254
  v_mul_f32 v87, v87, v255
  v_mul_f32 v88, v88, v252
  v_mul_f32 v89, v89, v253
  v_mul_f32 v90, v90, v254
  v_mul_f32 v91, v91, v255
  v_mul_f32 v92, v92, v252
  v_mul_f32 v93, v93, v253
  v_mul_f32 v94, v94, v254
  v_mul_f32 v95, v95, v255
  v_max3_f32 v246, v176, v177, v178
  v_max3_f32 v247, v179, v180, v181
  v_max3_f32 v246, v246, v182, v183
  v_max3_f32 v247, v247, v184, v185
  v_max3_f32 v246, v246, v186, v187
  v_max3_f32 v247, v247, v188, v189
  v_max3_f32 v246, v246, v190, v191
  v_max_f32 v246, v246, v247
  v_mov_b32 v247, v246
  s_nop 1
  v_permlane16_swap_b32 v246, v247
  s_nop 1
  v_max_f32 v246, v246, v247
  v_mov_b32 v247, v246
  s_nop 1
  v_permlane32_swap_b32 v246, v247
  s_nop 1
  v_max_f32 v246, v246, v247
  v_max_f32 v246, 0, v246
  v_exp_f32 v248, -v246
  v_sub_f32 v204, v204, v246
  v_sub_f32 v205, v205, v246
  v_sub_f32 v206, v206, v246
  v_sub_f32 v207, v207, v246
  v_mul_f32 v245, v245, v248
  ds_bpermute_b32 v252, v240, v248 offset:0
  ds_bpermute_b32 v253, v240, v248 offset:4
  ds_bpermute_b32 v254, v240, v248 offset:8
  ds_bpermute_b32 v255, v240, v248 offset:12
  v_sub_f32 v176, v176, v246
  v_sub_f32 v177, v177, v246
  v_sub_f32 v178, v178, v246
  v_sub_f32 v179, v179, v246
  v_sub_f32 v180, v180, v246
  v_sub_f32 v181, v181, v246
  v_sub_f32 v182, v182, v246
  v_sub_f32 v183, v183, v246
  v_sub_f32 v184, v184, v246
  v_sub_f32 v185, v185, v246
  v_sub_f32 v186, v186, v246
  v_sub_f32 v187, v187, v246
  v_sub_f32 v188, v188, v246
  v_sub_f32 v189, v189, v246
  v_sub_f32 v190, v190, v246
  v_sub_f32 v191, v191, v246
  s_waitcnt lgkmcnt(0)
  v_mul_f32 v96, v96, v252
  v_mul_f32 v97, v97, v253
  v_mul_f32 v98, v98, v254
  v_mul_f32 v99, v99, v255
  v_mul_f32 v100, v100, v252
  v_mul_f32 v101, v101, v253
  v_mul_f32 v102, v102, v254
  v_mul_f32 v103, v103, v255
  v_mul_f32 v104, v104, v252
  v_mul_f32 v105, v105, v253
  v_mul_f32 v106, v106, v254
  v_mul_f32 v107, v107, v255
  v_mul_f32 v108, v108, v252
  v_mul_f32 v109, v109, v253
  v_mul_f32 v110, v110, v254
  v_mul_f32 v111, v111, v255
  v_mul_f32 v112, v112, v252
  v_mul_f32 v113, v113, v253
  v_mul_f32 v114, v114, v254
  v_mul_f32 v115, v115, v255
  v_mul_f32 v116, v116, v252
  v_mul_f32 v117, v117, v253
  v_mul_f32 v118, v118, v254
  v_mul_f32 v119, v119, v255
  v_mul_f32 v120, v120, v252
  v_mul_f32 v121, v121, v253
  v_mul_f32 v122, v122, v254
  v_mul_f32 v123, v123, v255
  v_mul_f32 v124, v124, v252
  v_mul_f32 v125, v125, v253
  v_mul_f32 v126, v126, v254
  v_mul_f32 v127, v127, v255
  v_exp_f32 v160, v160
  v_exp_f32 v161, v161
  v_exp_f32 v162, v162
  v_cvt_pk_bf16_f32 v160, v160, v161
  v_exp_f32 v163, v163
  v_exp_f32 v164, v164
  v_cvt_pk_bf16_f32 v161, v162, v163
  v_exp_f32 v165, v165
  v_exp_f32 v166, v166
  v_cvt_pk_bf16_f32 v162, v164, v165
  v_exp_f32 v167, v167
  v_exp_f32 v168, v168
  v_cvt_pk_bf16_f32 v163, v166, v167
  s_nop 1
  v_mfma_f32_16x16x32_bf16 v[216:219], a[192:195], v[160:163], 0
  v_exp_f32 v169, v169
  v_exp_f32 v170, v170
  v_cvt_pk_bf16_f32 v168, v168, v169
  v_exp_f32 v171, v171
  v_exp_f32 v172, v172
  v_cvt_pk_bf16_f32 v169, v170, v171
  v_exp_f32 v173, v173
  v_exp_f32 v174, v174
  v_cvt_pk_bf16_f32 v170, v172, v173
  v_exp_f32 v175, v175
  v_exp_f32 v176, v176
  v_cvt_pk_bf16_f32 v171, v174, v175
  s_nop 1
  v_mfma_f32_16x16x32_bf16 v[216:219], a[192:195], v[168:171], v[216:219]
  v_exp_f32 v177, v177
  v_exp_f32 v178, v178
  v_cvt_pk_bf16_f32 v176, v176, v177
  v_exp_f32 v179, v179
  v_exp_f32 v180, v180
  v_cvt_pk_bf16_f32 v177, v178, v179
  v_exp_f32 v181, v181
  v_exp_f32 v182, v182
  v_cvt_pk_bf16_f32 v178, v180, v181
  v_exp_f32 v183, v183
  v_exp_f32 v184, v184
  v_cvt_pk_bf16_f32 v179, v182, v183
  s_nop 1
  v_mfma_f32_16x16x32_bf16 v[220:223], a[192:195], v[176:179], 0
  v_exp_f32 v185, v185
  v_exp_f32 v186, v186
  v_cvt_pk_bf16_f32 v184, v184, v185
  v_exp_f32 v187, v187
  v_exp_f32 v188, v188
  v_cvt_pk_bf16_f32 v185, v186, v187
  v_exp_f32 v189, v189
  v_exp_f32 v190, v190
  v_cvt_pk_bf16_f32 v186, v188, v189
  v_exp_f32 v191, v191
  s_nop 0
  v_cvt_pk_bf16_f32 v187, v190, v191
  s_nop 1
  v_mfma_f32_16x16x32_bf16 v[220:223], a[192:195], v[184:187], v[220:223]
  s_nop 7
  s_branch L_slow_1_ret
L_slow_z0:
  s_nop 3
  s_waitcnt lgkmcnt(0)
  v_mfma_f32_16x16x32_bf16 v[128:131], a[64:67], a[0:3], v[192:195]
  v_mfma_f32_16x16x32_bf16 v[128:131], a[68:71], a[4:7], v[128:131]
  v_mfma_f32_16x16x32_bf16 v[128:131], a[72:75], a[8:11], v[128:131]
  v_mfma_f32_16x16x32_bf16 v[128:131], a[76:79], a[12:15], v[128:131]
  v_mfma_f32_16x16x32_bf16 v[132:135], a[80:83], a[0:3], v[192:195]
  v_mfma_f32_16x16x32_bf16 v[132:135], a[84:87], a[4:7], v[132:135]
  v_mfma_f32_16x16x32_bf16 v[132:135], a[88:91], a[8:11], v[132:135]
  v_mfma_f32_16x16x32_bf16 v[132:135], a[92:95], a[12:15], v[132:135]
  v_mfma_f32_16x16x32_bf16 v[136:139], a[96:99], a[0:3], v[192:195]
  v_mfma_f32_16x16x32_bf16 v[136:139], a[100:103], a[4:7], v[136:139]
  v_mfma_f32_16x16x32_bf16 v[136:139], a[104:107], a[8:11], v[136:139]
  v_mfma_f32_16x16x32_bf16 v[136:139], a[108:111], a[12:15], v[136:139]
  v_mfma_f32_16x16x32_bf16 v[140:143], a[112:115], a[0:3], v[192:195]
  v_mfma_f32_16x16x32_bf16 v[140:143], a[116:119], a[4:7], v[140:143]
  v_mfma_f32_16x16x32_bf16 v[140:143], a[120:123], a[8:11], v[140:143]
  v_mfma_f32_16x16x32_bf16 v[140:143], a[124:127], a[12:15], v[140:143]
  s_nop 7
  v_max3_f32 v246, v128, v129, v130
  v_max3_f32 v247, v131, v132, v133
  v_max3_f32 v246, v246, v134, v135
  v_max3_f32 v247, v247, v136, v137
  v_max3_f32 v246, v246, v138, v139
  v_max3_f32 v247, v247, v140, v141
  v_max3_f32 v246, v246, v142, v143
  v_max_f32 v246, v246, v247
  v_mov_b32 v247, v246
  s_nop 1
  v_permlane16_swap_b32 v246, v247
  s_nop 1
  v_max_f32 v246, v246, v247
  v_mov_b32 v247, v246
  s_nop 1
  v_permlane32_swap_b32 v246, v247
  s_nop 1
  v_max_f32 v246, v246, v247
  v_max_f32 v246, 0, v246
  v_exp_f32 v248, -v246
  v_sub_f32 v192, v192, v246
  v_sub_f32 v193, v193, v246
  v_sub_f32 v194, v194, v246
  v_sub_f32 v195, v195, v246
  v_mul_f32 v242, v242, v248
  ds_bpermute_b32 v252, v240, v248 offset:0
  ds_bpermute_b32 v253, v240, v248 offset:4
  ds_bpermute_b32 v254, v240, v248 offset:8
  ds_bpermute_b32 v255, v240, v248 offset:12
  v_sub_f32 v128, v128, v246
  v_sub_f32 v129, v129, v246
  v_sub_f32 v130, v130, v246
  v_sub_f32 v131, v131, v246
  v_sub_f32 v132, v132, v246
  v_sub_f32 v133, v133, v246
  v_sub_f32 v134, v134, v246
  v_sub_f32 v135, v135, v246
  v_sub_f32 v136, v136, v246
  v_sub_f32 v137, v137, v246
  v_sub_f32 v138, v138, v246
  v_sub_f32 v139, v139, v246
  v_sub_f32 v140, v140, v246
  v_sub_f32 v141, v141, v246
  v_sub_f32 v142, v142, v246
  v_sub_f32 v143, v143, v246
  s_waitcnt lgkmcnt(0)
  v_mul_f32 v0, v0, v252
  v_mul_f32 v1, v1, v253
  v_mul_f32 v2, v2, v254
  v_mul_f32 v3, v3, v255
  v_mul_f32 v4, v4, v252
  v_mul_f32 v5, v5, v253
  v_mul_f32 v6, v6, v254
  v_mul_f32 v7, v7, v255
  v_mul_f32 v8, v8, v252
  v_mul_f32 v9, v9, v253
  v_mul_f32 v10, v10, v254
  v_mul_f32 v11, v11, v255
  v_mul_f32 v12, v12, v252
  v_mul_f32 v13, v13, v253
  v_mul_f32 v14, v14, v254
  v_mul_f32 v15, v15, v255
  v_mul_f32 v16, v16, v252
  v_mul_f32 v17, v17, v253
  v_mul_f32 v18, v18, v254
  v_mul_f32 v19, v19, v255
  v_mul_f32 v20, v20, v252
  v_mul_f32 v21, v21, v253
  v_mul_f32 v22, v22, v254
  v_mul_f32 v23, v23, v255
  v_mul_f32 v24, v24, v252
  v_mul_f32 v25, v25, v253
  v_mul_f32 v26, v26, v254
  v_mul_f32 v27, v27, v255
  v_mul_f32 v28, v28, v252
  v_mul_f32 v29, v29, v253
  v_mul_f32 v30, v30, v254
  v_mul_f32 v31, v31, v255
  v_exp_f32 v128, v128
  v_exp_f32 v129, v129
  v_exp_f32 v130, v130
  v_cvt_pk_bf16_f32 v128, v128, v129
  v_exp_f32 v131, v131
  v_exp_f32 v132, v132
  v_cvt_pk_bf16_f32 v129, v130, v131
  v_exp_f32 v133, v133
  v_exp_f32 v134, v134
  v_cvt_pk_bf16_f32 v130, v132, v133
  v_exp_f32 v135, v135
  v_exp_f32 v136, v136
  v_cvt_pk_bf16_f32 v131, v134, v135
  s_nop 1
  v_mfma_f32_16x16x32_bf16 v[208:211], a[192:195], v[128:131], 0
  v_exp_f32 v137, v137
  v_exp_f32 v138, v138
  v_cvt_pk_bf16_f32 v136, v136, v137
  v_exp_f32 v139, v139
  v_exp_f32 v140, v140
  v_cvt_pk_bf16_f32 v137, v138, v139
  v_exp_f32 v141, v141
  v_exp_f32 v142, v142
  v_cvt_pk_bf16_f32 v138, v140, v141
  v_exp_f32 v143, v143
  s_nop 0
  v_cvt_pk_bf16_f32 v139, v142, v143
  s_nop 1
  v_mfma_f32_16x16x32_bf16 v[208:211], a[192:195], v[136:139], v[208:211]
  s_nop 7
  s_branch L_slow_z0_ret
L_slow_z1:
  s_nop 3
  s_waitcnt lgkmcnt(0)
  v_mfma_f32_16x16x32_bf16 v[144:147], a[64:67], a[16:19], v[196:199]
  v_mfma_f32_16x16x32_bf16 v[144:147], a[68:71], a[20:23], v[144:147]
  v_mfma_f32_16x16x32_bf16 v[144:147], a[72:75], a[24:27], v[144:147]
  v_mfma_f32_16x16x32_bf16 v[144:147], a[76:79], a[28:31], v[144:147]
  v_mfma_f32_16x16x32_bf16 v[148:151], a[80:83], a[16:19], v[196:199]
  v_mfma_f32_16x16x32_bf16 v[148:151], a[84:87], a[20:23], v[148:151]
  v_mfma_f32_16x16x32_bf16 v[148:151], a[88:91], a[24:27], v[148:151]
  v_mfma_f32_16x16x32_bf16 v[148:151], a[92:95], a[28:31], v[148:151]
  v_mfma_f32_16x16x32_bf16 v[152:155], a[96:99], a[16:19], v[196:199]
  v_mfma_f32_16x16x32_bf16 v[152:155], a[100:103], a[20:23], v[152:155]
  v_mfma_f32_16x16x32_bf16 v[152:155], a[104:107], a[24:27], v[152:155]
  v_mfma_f32_16x16x32_bf16 v[152:155], a[108:111], a[28:31], v[152:155]
  v_mfma_f32_16x16x32_bf16 v[156:159], a[112:115], a[16:19], v[196:199]
  v_mfma_f32_16x16x32_bf16 v[156:159], a[116:119], a[20:23], v[156:159]
  v_mfma_f32_16x16x32_bf16 v[156:159], a[120:123], a[24:27], v[156:159]
  v_mfma_f32_16x16x32_bf16 v[156:159], a[124:127], a[28:31], v[156:159]
  s_nop 7
  v_max3_f32 v246, v144, v145, v146
  v_max3_f32 v247, v147, v148, v149
  v_max3_f32 v246, v246, v150, v151
  v_max3_f32 v247, v247, v152, v153
  v_max3_f32 v246, v246, v154, v155
  v_max3_f32 v247, v247, v156, v157
  v_max3_f32 v246, v246, v158, v159
  v_max_f32 v246, v246, v247
  v_mov_b32 v247, v246
  s_nop 1
  v_permlane16_swap_b32 v246, v247
  s_nop 1
  v_max_f32 v246, v246, v247
  v_mov_b32 v247, v246
  s_nop 1
  v_permlane32_swap_b32 v246, v247
  s_nop 1
  v_max_f32 v246, v246, v247
  v_max_f32 v246, 0, v246
  v_exp_f32 v248, -v246
  v_sub_f32 v196, v196, v246
  v_sub_f32 v197, v197, v246
  v_sub_f32 v198, v198, v246
  v_sub_f32 v199, v199, v246
  v_mul_f32 v243, v243, v248
  ds_bpermute_b32 v252, v240, v248 offset:0
  ds_bpermute_b32 v253, v240, v248 offset:4
  ds_bpermute_b32 v254, v240, v248 offset:8
  ds_bpermute_b32 v255, v240, v248 offset:12
  v_sub_f32 v144, v144, v246
  v_sub_f32 v145, v145, v246
  v_sub_f32 v146, v146, v246
  v_sub_f32 v147, v147, v246
  v_sub_f32 v148, v148, v246
  v_sub_f32 v149, v149, v246
  v_sub_f32 v150, v150, v246
  v_sub_f32 v151, v151, v246
  v_sub_f32 v152, v152, v246
  v_sub_f32 v153, v153, v246
  v_sub_f32 v154, v154, v246
  v_sub_f32 v155, v155, v246
  v_sub_f32 v156, v156, v246
  v_sub_f32 v157, v157, v246
  v_sub_f32 v158, v158, v246
  v_sub_f32 v159, v159, v246
  s_waitcnt lgkmcnt(0)
  v_mul_f32 v32, v32, v252
  v_mul_f32 v33, v33, v253
  v_mul_f32 v34, v34, v254
  v_mul_f32 v35, v35, v255
  v_mul_f32 v36, v36, v252
  v_mul_f32 v37, v37, v253
  v_mul_f32 v38, v38, v254
  v_mul_f32 v39, v39, v255
  v_mul_f32 v40, v40, v252
  v_mul_f32 v41, v41, v253
  v_mul_f32 v42, v42, v254
  v_mul_f32 v43, v43, v255
  v_mul_f32 v44, v44, v252
  v_mul_f32 v45, v45, v253
  v_mul_f32 v46, v46, v254
  v_mul_f32 v47, v47, v255
  v_mul_f32 v48, v48, v252
  v_mul_f32 v49, v49, v253
  v_mul_f32 v50, v50, v254
  v_mul_f32 v51, v51, v255
  v_mul_f32 v52, v52, v252
  v_mul_f32 v53, v53, v253
  v_mul_f32 v54, v54, v254
  v_mul_f32 v55, v55, v255
  v_mul_f32 v56, v56, v252
  v_mul_f32 v57, v57, v253
  v_mul_f32 v58, v58, v254
  v_mul_f32 v59, v59, v255
  v_mul_f32 v60, v60, v252
  v_mul_f32 v61, v61, v253
  v_mul_f32 v62, v62, v254
  v_mul_f32 v63, v63, v255
  v_exp_f32 v144, v144
  v_exp_f32 v145, v145
  v_exp_f32 v146, v146
  v_cvt_pk_bf16_f32 v144, v144, v145
  v_exp_f32 v147, v147
  v_exp_f32 v148, v148
  v_cvt_pk_bf16_f32 v145, v146, v147
  v_exp_f32 v149, v149
  v_exp_f32 v150, v150
  v_cvt_pk_bf16_f32 v146, v148, v149
  v_exp_f32 v151, v151
  v_exp_f32 v152, v152
  v_cvt_pk_bf16_f32 v147, v150, v151
  s_nop 1
  v_mfma_f32_16x16x32_bf16 v[212:215], a[192:195], v[144:147], 0
  v_exp_f32 v153, v153
  v_exp_f32 v154, v154
  v_cvt_pk_bf16_f32 v152, v152, v153
  v_exp_f32 v155, v155
  v_exp_f32 v156, v156
  v_cvt_pk_bf16_f32 v153, v154, v155
  v_exp_f32 v157, v157
  v_exp_f32 v158, v158
  v_cvt_pk_bf16_f32 v154, v156, v157
  v_exp_f32 v159, v159
  s_nop 0
  v_cvt_pk_bf16_f32 v155, v158, v159
  s_nop 1
  v_mfma_f32_16x16x32_bf16 v[212:215], a[192:195], v[152:155], v[212:215]
  s_nop 7
  s_branch L_slow_z1_ret
L_slow_z4:
  s_nop 3
  s_waitcnt lgkmcnt(0)
  v_mfma_f32_16x16x32_bf16 v[160:163], a[64:67], a[32:35], v[200:203]
  v_mfma_f32_16x16x32_bf16 v[160:163], a[68:71], a[36:39], v[160:163]
  v_mfma_f32_16x16x32_bf16 v[160:163], a[72:75], a[40:43], v[160:163]
  v_mfma_f32_16x16x32_bf16 v[160:163], a[76:79], a[44:47], v[160:163]
  v_mfma_f32_16x16x32_bf16 v[164:167], a[80:83], a[32:35], v[200:203]
  v_mfma_f32_16x16x32_bf16 v[164:167], a[84:87], a[36:39], v[164:167]
  v_mfma_f32_16x16x32_bf16 v[164:167], a[88:91], a[40:43], v[164:167]
  v_mfma_f32_16x16x32_bf16 v[164:167], a[92:95], a[44:47], v[164:167]
  v_mfma_f32_16x16x32_bf16 v[168:171], a[96:99], a[32:35], v[200:203]
  v_mfma_f32_16x16x32_bf16 v[168:171], a[100:103], a[36:39], v[168:171]
  v_mfma_f32_16x16x32_bf16 v[168:171], a[104:107], a[40:43], v[168:171]
  v_mfma_f32_16x16x32_bf16 v[168:171], a[108:111], a[44:47], v[168:171]
  v_mfma_f32_16x16x32_bf16 v[172:175], a[112:115], a[32:35], v[200:203]
  v_mfma_f32_16x16x32_bf16 v[172:175], a[116:119], a[36:39], v[172:175]
  v_mfma_f32_16x16x32_bf16 v[172:175], a[120:123], a[40:43], v[172:175]
  v_mfma_f32_16x16x32_bf16 v[172:175], a[124:127], a[44:47], v[172:175]
  s_nop 7
  v_max3_f32 v246, v160, v161, v162
  v_max3_f32 v247, v163, v164, v165
  v_max3_f32 v246, v246, v166, v167
  v_max3_f32 v247, v247, v168, v169
  v_max3_f32 v246, v246, v170, v171
  v_max3_f32 v247, v247, v172, v173
  v_max3_f32 v246, v246, v174, v175
  v_max_f32 v246, v246, v247
  v_mov_b32 v247, v246
  s_nop 1
  v_permlane16_swap_b32 v246, v247
  s_nop 1
  v_max_f32 v246, v246, v247
  v_mov_b32 v247, v246
  s_nop 1
  v_permlane32_swap_b32 v246, v247
  s_nop 1
  v_max_f32 v246, v246, v247
  v_max_f32 v246, 0, v246
  v_exp_f32 v248, -v246
  v_sub_f32 v200, v200, v246
  v_sub_f32 v201, v201, v246
  v_sub_f32 v202, v202, v246
  v_sub_f32 v203, v203, v246
  v_mul_f32 v244, v244, v248
  ds_bpermute_b32 v252, v240, v248 offset:0
  ds_bpermute_b32 v253, v240, v248 offset:4
  ds_bpermute_b32 v254, v240, v248 offset:8
  ds_bpermute_b32 v255, v240, v248 offset:12
  v_sub_f32 v160, v160, v246
  v_sub_f32 v161, v161, v246
  v_sub_f32 v162, v162, v246
  v_sub_f32 v163, v163, v246
  v_sub_f32 v164, v164, v246
  v_sub_f32 v165, v165, v246
  v_sub_f32 v166, v166, v246
  v_sub_f32 v167, v167, v246
  v_sub_f32 v168, v168, v246
  v_sub_f32 v169, v169, v246
  v_sub_f32 v170, v170, v246
  v_sub_f32 v171, v171, v246
  v_sub_f32 v172, v172, v246
  v_sub_f32 v173, v173, v246
  v_sub_f32 v174, v174, v246
  v_sub_f32 v175, v175, v246
  s_waitcnt lgkmcnt(0)
  v_mul_f32 v64, v64, v252
  v_mul_f32 v65, v65, v253
  v_mul_f32 v66, v66, v254
  v_mul_f32 v67, v67, v255
  v_mul_f32 v68, v68, v252
  v_mul_f32 v69, v69, v253
  v_mul_f32 v70, v70, v254
  v_mul_f32 v71, v71, v255
  v_mul_f32 v72, v72, v252
  v_mul_f32 v73, v73, v253
  v_mul_f32 v74, v74, v254
  v_mul_f32 v75, v75, v255
  v_mul_f32 v76, v76, v252
  v_mul_f32 v77, v77, v253
  v_mul_f32 v78, v78, v254
  v_mul_f32 v79, v79, v255
  v_mul_f32 v80, v80, v252
  v_mul_f32 v81, v81, v253
  v_mul_f32 v82, v82, v254
  v_mul_f32 v83, v83, v255
  v_mul_f32 v84, v84, v252
  v_mul_f32 v85, v85, v253
  v_mul_f32 v86, v86, v254
  v_mul_f32 v87, v87, v255
  v_mul_f32 v88, v88, v252
  v_mul_f32 v89, v89, v253
  v_mul_f32 v90, v90, v254
  v_mul_f32 v91, v91, v255
  v_mul_f32 v92, v92, v252
  v_mul_f32 v93, v93, v253
  v_mul_f32 v94, v94, v254
  v_mul_f32 v95, v95, v255
  v_exp_f32 v160, v160
  v_exp_f32 v161, v161
  v_exp_f32 v162, v162
  v_cvt_pk_bf16_f32 v160, v160, v161
  v_exp_f32 v163, v163
  v_exp_f32 v164, v164
  v_cvt_pk_bf16_f32 v161, v162, v163
  v_exp_f32 v165, v165
  v_exp_f32 v166, v166
  v_cvt_pk_bf16_f32 v162, v164, v165
  v_exp_f32 v167, v167
  v_exp_f32 v168, v168
  v_cvt_pk_bf16_f32 v163, v166, v167
  s_nop 1
  v_mfma_f32_16x16x32_bf16 v[216:219], a[192:195], v[160:163], 0
  v_exp_f32 v169, v169
  v_exp_f32 v170, v170
  v_cvt_pk_bf16_f32 v168, v168, v169
  v_exp_f32 v171, v171
  v_exp_f32 v172, v172
  v_cvt_pk_bf16_f32 v169, v170, v171
  v_exp_f32 v173, v173
  v_exp_f32 v174, v174
  v_cvt_pk_bf16_f32 v170, v172, v173
  v_exp_f32 v175, v175
  s_nop 0
  v_cvt_pk_bf16_f32 v171, v174, v175
  s_nop 1
  v_mfma_f32_16x16x32_bf16 v[216:219], a[192:195], v[168:171], v[216:219]
  s_nop 7
  s_branch L_slow_z4_ret
L_slow_z5:
  s_nop 3
  s_waitcnt lgkmcnt(0)
  v_mfma_f32_16x16x32_bf16 v[176:179], a[64:67], a[48:51], v[204:207]
  v_mfma_f32_16x16x32_bf16 v[176:179], a[68:71], a[52:55], v[176:179]
  v_mfma_f32_16x16x32_bf16 v[176:179], a[72:75], a[56:59], v[176:179]
  v_mfma_f32_16x16x32_bf16 v[176:179], a[76:79], a[60:63], v[176:179]
  v_mfma_f32_16x16x32_bf16 v[180:183], a[80:83], a[48:51], v[204:207]
  v_mfma_f32_16x16x32_bf16 v[180:183], a[84:87], a[52:55], v[180:183]
  v_mfma_f32_16x16x32_bf16 v[180:183], a[88:91], a[56:59], v[180:183]
  v_mfma_f32_16x16x32_bf16 v[180:183], a[92:95], a[60:63], v[180:183]
  v_mfma_f32_16x16x32_bf16 v[184:187], a[96:99], a[48:51], v[204:207]
  v_mfma_f32_16x16x32_bf16 v[184:187], a[100:103], a[52:55], v[184:187]
  v_mfma_f32_16x16x32_bf16 v[184:187], a[104:107], a[56:59], v[184:187]
  v_mfma_f32_16x16x32_bf16 v[184:187], a[108:111], a[60:63], v[184:187]
  v_mfma_f32_16x16x32_bf16 v[188:191], a[112:115], a[48:51], v[204:207]
  v_mfma_f32_16x16x32_bf16 v[188:191], a[116:119], a[52:55], v[188:191]
  v_mfma_f32_16x16x32_bf16 v[188:191], a[120:123], a[56:59], v[188:191]
  v_mfma_f32_16x16x32_bf16 v[188:191], a[124:127], a[60:63], v[188:191]
  s_nop 7
  v_max3_f32 v246, v176, v177, v178
  v_max3_f32 v247, v179, v180, v181
  v_max3_f32 v246, v246, v182, v183
  v_max3_f32 v247, v247, v184, v185
  v_max3_f32 v246, v246, v186, v187
  v_max3_f32 v247, v247, v188, v189
  v_max3_f32 v246, v246, v190, v191
  v_max_f32 v246, v246, v247
  v_mov_b32 v247, v246
  s_nop 1
  v_permlane16_swap_b32 v246, v247
  s_nop 1
  v_max_f32 v246, v246, v247
  v_mov_b32 v247, v246
  s_nop 1
  v_permlane32_swap_b32 v246, v247
  s_nop 1
  v_max_f32 v246, v246, v247
  v_max_f32 v246, 0, v246
  v_exp_f32 v248, -v246
  v_sub_f32 v204, v204, v246
  v_sub_f32 v205, v205, v246
  v_sub_f32 v206, v206, v246
  v_sub_f32 v207, v207, v246
  v_mul_f32 v245, v245, v248
  ds_bpermute_b32 v252, v240, v248 offset:0
  ds_bpermute_b32 v253, v240, v248 offset:4
  ds_bpermute_b32 v254, v240, v248 offset:8
  ds_bpermute_b32 v255, v240, v248 offset:12
  v_sub_f32 v176, v176, v246
  v_sub_f32 v177, v177, v246
  v_sub_f32 v178, v178, v246
  v_sub_f32 v179, v179, v246
  v_sub_f32 v180, v180, v246
  v_sub_f32 v181, v181, v246
  v_sub_f32 v182, v182, v246
  v_sub_f32 v183, v183, v246
  v_sub_f32 v184, v184, v246
  v_sub_f32 v185, v185, v246
  v_sub_f32 v186, v186, v246
  v_sub_f32 v187, v187, v246
  v_sub_f32 v188, v188, v246
  v_sub_f32 v189, v189, v246
  v_sub_f32 v190, v190, v246
  v_sub_f32 v191, v191, v246
  s_waitcnt lgkmcnt(0)
  v_mul_f32 v96, v96, v252
  v_mul_f32 v97, v97, v253
  v_mul_f32 v98, v98, v254
  v_mul_f32 v99, v99, v255
  v_mul_f32 v100, v100, v252
  v_mul_f32 v101, v101, v253
  v_mul_f32 v102, v102, v254
  v_mul_f32 v103, v103, v255
  v_mul_f32 v104, v104, v252
  v_mul_f32 v105, v105, v253
  v_mul_f32 v106, v106, v254
  v_mul_f32 v107, v107, v255
  v_mul_f32 v108, v108, v252
  v_mul_f32 v109, v109, v253
  v_mul_f32 v110, v110, v254
  v_mul_f32 v111, v111, v255
  v_mul_f32 v112, v112, v252
  v_mul_f32 v113, v113, v253
  v_mul_f32 v114, v114, v254
  v_mul_f32 v115, v115, v255
  v_mul_f32 v116, v116, v252
  v_mul_f32 v117, v117, v253
  v_mul_f32 v118, v118, v254
  v_mul_f32 v119, v119, v255
  v_mul_f32 v120, v120, v252
  v_mul_f32 v121, v121, v253
  v_mul_f32 v122, v122, v254
  v_mul_f32 v123, v123, v255
  v_mul_f32 v124, v124, v252
  v_mul_f32 v125, v125, v253
  v_mul_f32 v126, v126, v254
  v_mul_f32 v127, v127, v255
  v_exp_f32 v176, v176
  v_exp_f32 v177, v177
  v_exp_f32 v178, v178
  v_cvt_pk_bf16_f32 v176, v176, v177
  v_exp_f32 v179, v179
  v_exp_f32 v180, v180
  v_cvt_pk_bf16_f32 v177, v178, v179
  v_exp_f32 v181, v181
  v_exp_f32 v182, v182
  v_cvt_pk_bf16_f32 v178, v180, v181
  v_exp_f32 v183, v183
  v_exp_f32 v184, v184
  v_cvt_pk_bf16_f32 v179, v182, v183
  s_nop 1
  v_mfma_f32_16x16x32_bf16 v[220:223], a[192:195], v[176:179], 0
  v_exp_f32 v185, v185
  v_exp_f32 v186, v186
  v_cvt_pk_bf16_f32 v184, v184, v185
  v_exp_f32 v187, v187
  v_exp_f32 v188, v188
  v_cvt_pk_bf16_f32 v185, v186, v187
  v_exp_f32 v189, v189
  v_exp_f32 v190, v190
  v_cvt_pk_bf16_f32 v186, v188, v189
  v_exp_f32 v191, v191
  s_nop 0
  v_cvt_pk_bf16_f32 v187, v190, v191
  s_nop 1
  v_mfma_f32_16x16x32_bf16 v[220:223], a[192:195], v[184:187], v[220:223]
  s_nop 7
  s_branch L_slow_z5_ret
.section .rodata,"a"
.p2align 6
.amdhsa_kernel standalone__gqa_softmax__near_ridge_kernel
  .amdhsa_next_free_vgpr 512
  .amdhsa_next_free_sgpr 64
  .amdhsa_accum_offset 256
  .amdhsa_group_segment_fixed_size 0
  .amdhsa_kernarg_size 48
  .amdhsa_user_sgpr_count 2
  .amdhsa_user_sgpr_kernarg_segment_ptr 1
  .amdhsa_system_sgpr_workgroup_id_x 1
.end_amdhsa_kernel
```
